```python
import torch

def _softmax(x, axis=-1):
    return torch.softmax(x, dim=axis)
def _gelu(x):
    return torch.nn.functional.gelu(x, approximate="tanh")
def _silu(x):
    return torch.nn.functional.silu(x)
def _sigmoid(x):
    return torch.sigmoid(x)
def _layernorm(x, axis=-1, eps=1e-5):
    m = x.mean(dim=axis, keepdim=True)
    v = x.var(dim=axis, keepdim=True, unbiased=False)
    return (x - m) / torch.sqrt(v + eps)
def _scatter_add(tgt, idx, src, axis=0):
    return tgt.clone().index_add_(axis, idx, src)
def _segment_sum(src, seg, n):
    out = torch.zeros((n,) + src.shape[1:], dtype=src.dtype)
    return out.index_add_(0, seg, src)
def _pad(x, pw):
    flat = tuple(v for pair in reversed(pw) for v in pair)
    return torch.nn.functional.pad(x, flat)

kernel_name = 'recurrent_scan__mha_block__moe_arch_mod__prompt'

def setup_inputs():

    _w = (lambda a: (lambda t: t.to(torch.bfloat16) if t.is_floating_point() else t)(torch.as_tensor(a)))
    def _A_setup():
        B, S, D, H = 1, 2048, 512, 32
        return {
            "x": _w((lambda *s: torch.randn(*s, dtype=torch.bfloat16) * 0.05)(B, S, D)),
            "wqkv": _w((lambda *s: torch.randn(*s, dtype=torch.bfloat16) * 0.05)(D, 3 * D)),
            "wo": _w((lambda *s: torch.randn(*s, dtype=torch.bfloat16) * 0.05)(D, D)),
        }
    _A_in = _A_setup()

    def _B_setup():
        B, S, D, F, C = 1, 2048, 512, 1792, 8
        return {
            "x": _w((lambda *s: torch.randn(*s, dtype=torch.bfloat16) * 0.05)(B, S, D)),
            "w_r": _w((lambda *s: torch.randn(*s, dtype=torch.bfloat16) * 0.05)(D)),
            "w_gate": _w((lambda *s: torch.randn(*s, dtype=torch.bfloat16) * 0.05)(D, F)),
            "w_up": _w((lambda *s: torch.randn(*s, dtype=torch.bfloat16) * 0.05)(D, F)),
            "w_down": _w((lambda *s: torch.randn(*s, dtype=torch.bfloat16) * 0.05)(F, D)),
        }
    _B_in = _B_setup()

    return {
        "A_x": _A_in["x"],
        "A_wqkv": _A_in["wqkv"],
        "A_wo": _A_in["wo"],
        "B_x": _B_in["x"],
        "B_w_r": _B_in["w_r"],
        "B_w_gate": _B_in["w_gate"],
        "B_w_up": _B_in["w_up"],
        "B_w_down": _B_in["w_down"],
    }

def reference(A_x, A_wqkv, A_wo, B_x, B_w_r, B_w_gate, B_w_up, B_w_down):
    def _A_ref(x, wqkv, wo):
        B, S, D = x.shape
        H = 32
        Dh = D // H
        qkv = (lambda x, *d: x.permute(*d))((x @ wqkv).reshape(B, S, 3, H, Dh), 2, 0, 3, 1, 4)
        q, k, v = qkv[0], qkv[1], qkv[2]
        scores = torch.einsum("bhqd,bhkd->bhqk", q, k) * (Dh ** -0.5)
        p = _softmax(scores, axis=-1)
        o = torch.einsum("bhqk,bhkd->bhqd", p, v)
        return (lambda x, *d: x.permute(*d))(o, 0, 2, 1, 3).reshape(B, S, D) @ wo

    def _B_ref(x, w_r, w_gate, w_up, w_down):
        B, S, D = x.shape
        C = 8
        r = x @ w_r
        idx = torch.argsort(-r, axis=-1)[:, :C]
        idx_e = (lambda x, n, axis: torch.repeat_interleave(x, n, dim=axis))(idx.reshape(B, C, 1), D, axis=2)
        x_sel = (lambda x, i, axis: torch.take_along_dim(x, i, dim=axis))(x, idx_e, axis=1)
        g = _silu(x_sel @ w_gate)
        u = x_sel @ w_up
        y = (g * u) @ w_down
        r_sel = _sigmoid((lambda x, i, axis: torch.take_along_dim(x, i, dim=axis))(r, idx, axis=1))
        y = y * r_sel.reshape(B, C, 1)
        b_off = (torch.arange(B) * S).reshape(B, 1)
        flat_idx = (idx + b_off).reshape(B * C)
        zero = (x * 0.0).reshape(B * S, D)
        upd = _scatter_add(zero, flat_idx, y.reshape(B * C, D), axis=0)
        return x + upd.reshape(B, S, D)

    x = A_x
    xn = _layernorm(x, axis=-1)
    s = _A_ref(xn, A_wqkv, A_wo)
    g = _silu(_B_ref(xn, B_w_r, B_w_gate, B_w_up, B_w_down))
    return x + s * g
```

```asm
; @launch grid=(256,1,1) block=(512,1,1) lds=163840
.amdgcn_target "amdgcn-amd-amdhsa--gfx950"
.text
.globl recurrent_scan__mha_block__moe_arch_mod__prompt_kernel
.p2align 8
.type recurrent_scan__mha_block__moe_arch_mod__prompt_kernel,@function
recurrent_scan__mha_block__moe_arch_mod__prompt_kernel:
    s_cmp_ge_u32 s2, 0x100
    s_cbranch_scc1 L_END
    s_load_dwordx16 s[4:19], s[0:1], 0
    s_load_dwordx4 s[20:23], s[0:1], 64
    s_load_dwordx2 s[24:25], s[0:1], 80
    s_and_b32 s71, s2, 7
    s_xor_b32 s71, s71, 3
    s_lshr_b32 s74, s2, 3
    s_lshr_b32 s69, s74, 2
    s_and_b32 s72, s74, 3
    s_lshl_b32 s68, s71, 2
    s_add_u32 s68, s68, s72
    v_lshrrev_b32 v6, 6, v0
    v_and_b32 v1, 63, v0
    v_readfirstlane_b32 s70, v6
    v_lshlrev_b32 v2, 4, v1
    s_lshl_b32 s78, s69, 2
    s_add_u32 s78, s78, s72
    v_lshrrev_b32 v6, 4, v0
    v_lshlrev_b32 v6, 10, v6
    v_and_b32 v7, 15, v0
    v_lshl_add_u32 v18, v7, 4, v6
    s_lshl_b32 s75, s69, 3
    s_add_u32 s75, s75, s71
    s_lshl_b32 s75, s75, 15
    s_lshl_b32 s76, s72, 8
    s_add_u32 s27, s75, s76
    s_add_u32 s85, s78, s71
    s_and_b32 s85, s85, 7
    s_cmp_lt_u32 s70, 4
    s_cbranch_scc1 L_GEMM
    s_movk_i32 s73, 3072
    s_sub_u32 s74, s70, 4
    v_lshrrev_b32 v6, 4, v1
    v_and_b32 v7, 7, v1
    v_xor_b32 v8, v6, v7
    v_lshlrev_b32 v8, 4, v8
    v_lshrrev_b32 v9, 3, v1
    v_lshl_add_u32 v20, v9, 10, v8
    v_xor_b32 v21, 64, v20
    v_add_u32 v21, 7168, v21
    v_lshlrev_b32 v8, 1, v6
    v_xor_b32 v8, v8, v7
    v_lshlrev_b32 v8, 4, v8
    v_mul_lo_u32 v22, v6, s73
    v_add_u32 v22, v22, v8
    v_bfe_u32 v8, v1, 3, 1
    v_lshl_add_u32 v22, v8, 10, v22
    v_add_u32 v23, 11264, v22
    v_add_u32 v24, 22528, v22
    v_add_u32 v25, 33792, v22
    v_and_b32 v8, 2, v9
    v_lshlrev_b32 v8, 1, v8
    v_xor_b32 v8, v8, v7
    v_lshlrev_b32 v8, 4, v8
    v_mul_lo_u32 v26, v9, s73
    v_add_u32 v26, v26, v8
    v_add_u32 v26, 2048, v26
    v_add_u32 v27, 23552, v26
    s_lshl_b32 s92, s78, 16
    s_lshl_b32 s75, s74, 14
    s_add_u32 s92, s92, s75
    s_lshl_b32 s75, s71, 7
    s_mul_i32 s93, s74, 49152
    s_add_u32 s93, s93, s75
    s_lshl_b32 s95, s74, 11
    s_lshl_b32 s96, s74, 12
    s_add_u32 s96, s96, 8192
    s_add_u32 s97, s95, 24576
    s_waitcnt lgkmcnt(0)
    s_mov_b32 s28, s4
    s_and_b32 s29, s5, 0xffff
    s_mov_b32 s30, 0x200000
    s_mov_b32 s31, 0x20000
    s_mov_b32 s32, s6
    s_and_b32 s33, s7, 0xffff
    s_mov_b32 s34, 0x180000
    s_mov_b32 s35, 0x20000
    s_mul_i32 s76, s85, 196608
    s_lshl_b32 s75, s85, 7
    s_add_u32 m0, s96, 0
    s_add_u32 s76, s76, s93
    buffer_load_dwordx4 v22, s[32:35], s76 offen offset:0 lds
    buffer_load_dwordx4 v23, s[32:35], s76 offen offset:1024 lds
    buffer_load_dwordx4 v24, s[32:35], s76 offen offset:2048 lds
    buffer_load_dwordx4 v25, s[32:35], s76 offen offset:3072 lds
    s_add_u32 m0, s95, 0
    s_add_u32 s75, s75, s92
    buffer_load_dwordx4 v20, s[28:31], s75 offen offset:0 lds
    buffer_load_dwordx4 v21, s[28:31], s75 offen offset:1024 lds
    s_add_u32 m0, s97, 0
    s_add_u32 s85, s85, 1
    buffer_load_dwordx4 v26, s[32:35], s76 offen offset:0 lds
    buffer_load_dwordx4 v27, s[32:35], s76 offen offset:1024 lds
    s_and_b32 s85, s85, 7
    s_load_dword s26, s[24:25], 0
    s_mul_i32 s76, s85, 196608
    s_lshl_b32 s75, s85, 7
    s_add_u32 m0, s96, 32768
    s_add_u32 s76, s76, s93
    buffer_load_dwordx4 v22, s[32:35], s76 offen offset:0 lds
    buffer_load_dwordx4 v23, s[32:35], s76 offen offset:1024 lds
    buffer_load_dwordx4 v24, s[32:35], s76 offen offset:2048 lds
    buffer_load_dwordx4 v25, s[32:35], s76 offen offset:3072 lds
    s_add_u32 m0, s95, 32768
    s_add_u32 s75, s75, s92
    buffer_load_dwordx4 v20, s[28:31], s75 offen offset:0 lds
    buffer_load_dwordx4 v21, s[28:31], s75 offen offset:1024 lds
    s_add_u32 m0, s97, 32768
    s_add_u32 s85, s85, 1
    buffer_load_dwordx4 v26, s[32:35], s76 offen offset:0 lds
    buffer_load_dwordx4 v27, s[32:35], s76 offen offset:1024 lds
    s_and_b32 s85, s85, 7
    s_mov_b32 s36, s24
    s_and_b32 s37, s25, 0xffff
    s_mov_b32 s38, 0x1000000
    s_mov_b32 s39, 0x20000
    s_mov_b32 s40, s8
    s_and_b32 s41, s9, 0xffff
    s_mov_b32 s42, 0x80000
    s_mov_b32 s43, 0x20000
    s_mov_b32 s44, s20
    s_and_b32 s45, s21, 0xffff
    s_mov_b32 s46, 0x200000
    s_mov_b32 s47, 0x20000
    s_mov_b32 s48, s14
    s_and_b32 s49, s15, 0xffff
    s_mov_b32 s50, 0x1c0000
    s_mov_b32 s51, 0x20000
    s_mov_b32 s52, s16
    s_and_b32 s53, s17, 0xffff
    s_mov_b32 s54, 0x1c0000
    s_mov_b32 s55, 0x20000
    s_mov_b32 s56, s18
    s_and_b32 s57, s19, 0xffff
    s_mov_b32 s58, 0x1c0000
    s_mov_b32 s59, 0x20000
    s_mov_b32 s64, s22
    s_and_b32 s65, s23, 0xffff
    s_mov_b32 s66, 0x100
    s_mov_b32 s67, 0x20000
    s_sub_u32 s75, s71, 0
    s_and_b32 s75, s75, 7
    s_mul_i32 s9, s75, 28
    s_lshr_b32 s75, s2, 3
    s_add_u32 s9, s9, s75
    s_cmp_lt_u32 s75, 28
    s_cselect_b32 s75, s9, 99
    s_cmp_lt_u32 s75, 56
    s_cselect_b32 s87, 1, 0
    s_mov_b32 s88, 0xffff
    s_mov_b32 s89, 0xffff
    s_mov_b32 s90, 0x3f803f80
    v_mov_b32 v4, v2
    v_and_b32 v6, 15, v1
    v_lshlrev_b32 v6, 4, v6
    v_lshrrev_b32 v7, 5, v1
    v_lshl_add_u32 v6, v7, 9, v6
    v_add_u32 v5, 1024, v6
    v_lshrrev_b32 v189, 4, v0
    v_lshlrev_b32 v189, 3, v189
    s_lshr_b32 s6, s27, 15
    s_lshl_b32 s6, s6, 8
    s_add_u32 s6, s6, 0x10000
    v_mov_b32 v6, 155648
    v_mov_b32 v7, 0
    ds_write2_b32 v6, v7, v7 offset0:0 offset1:1
    ds_write2_b32 v6, v7, v7 offset0:2 offset1:3
    ds_write2_b32 v6, v7, v7 offset0:4 offset1:5
    s_waitcnt lgkmcnt(0)
    s_mul_i32 s26, s26, 0x9E3779B1
    s_add_u32 s26, s26, 0x7F4A7C15
    s_and_b32 s75, s74, 1
    s_lshr_b32 s76, s74, 1
    s_lshl_b32 s98, s78, 1
    s_add_u32 s98, s98, s76
    s_lshl_b32 s79, s98, 8
    s_add_u32 s79, s79, 0x10000
    v_and_b32 v6, 31, v1
    v_lshlrev_b32 v55, 3, v6
    v_lshrrev_b32 v7, 5, v1
    v_lshlrev_b32 v56, 4, v6
    v_lshl_add_u32 v56, v7, 12, v56
    s_lshl_b32 s7, s71, 13
    s_lshl_b32 s76, s75, 9
    s_add_u32 s7, s7, s76
    s_add_u32 s7, s7, 0x700000
    s_lshl_b32 s76, s71, 8
    s_add_u32 s76, s76, 0xc000
    v_add_u32 v57, s76, v55
    s_lshl_b32 s76, s68, 3
    s_add_u32 s76, s76, s69
    s_lshl_b32 s77, s76, 13
    s_lshl_b32 s76, s76, 14
    s_lshl_b32 s75, s74, 10
    s_add_u32 s76, s76, s75
    s_add_u32 s76, s76, 0x100000
    s_lshl_b32 s75, s74, 11
    s_add_u32 s77, s77, s75
    s_add_u32 s77, s77, 0x9ffc00
    s_lshl_b32 s75, s68, 9
    s_add_u32 s75, s75, 0x400
    v_mov_b32 v8, s76
    v_mov_b32 v9, s77
    v_cmp_gt_u32 vcc, 8, v1
    s_nop 1
    v_cndmask_b32 v8, v9, v8, vcc
    v_mov_b32 v9, s75
    v_cmp_gt_u32 vcc, 24, v1
    s_nop 1
    v_cndmask_b32 v8, v9, v8, vcc
    v_lshl_add_u32 v54, v1, 7, v8
    s_getreg_b32 s94, hwreg(HW_REG_XCC_ID, 0, 4)
    s_cmp_lt_u32 s74, 2
    s_cselect_b64 s[4:5], -1, 1
    v_mov_b32 v39, s26
    v_mov_b32 v43, s26
    v_mov_b32 v47, s26
    v_mov_b32 v51, s26
    s_waitcnt vmcnt(8)
    s_barrier
    s_mul_i32 s76, s85, 196608
    s_lshl_b32 s75, s85, 7
    s_add_u32 m0, s96, 65536
    s_add_u32 s76, s76, s93
    buffer_load_dwordx4 v22, s[32:35], s76 offen offset:0 lds
    buffer_load_dwordx4 v23, s[32:35], s76 offen offset:1024 lds
    buffer_load_dwordx4 v24, s[32:35], s76 offen offset:2048 lds
    buffer_load_dwordx4 v25, s[32:35], s76 offen offset:3072 lds
    s_add_u32 m0, s95, 65536
    s_add_u32 s75, s75, s92
    buffer_load_dwordx4 v20, s[28:31], s75 offen offset:0 lds
    buffer_load_dwordx4 v21, s[28:31], s75 offen offset:1024 lds
    s_add_u32 m0, s97, 65536
    s_add_u32 s85, s85, 1
    buffer_load_dwordx4 v26, s[32:35], s76 offen offset:0 lds
    buffer_load_dwordx4 v27, s[32:35], s76 offen offset:1024 lds
    s_and_b32 s85, s85, 7
    s_waitcnt vmcnt(8)
    s_barrier
    s_mul_i32 s76, s85, 196608
    s_lshl_b32 s75, s85, 7
    s_add_u32 m0, s96, 0
    s_add_u32 s76, s76, s93
    buffer_load_dwordx4 v22, s[32:35], s76 offen offset:0 lds
    buffer_load_dwordx4 v23, s[32:35], s76 offen offset:1024 lds
    buffer_load_dwordx4 v24, s[32:35], s76 offen offset:2048 lds
    buffer_load_dwordx4 v25, s[32:35], s76 offen offset:3072 lds
    s_add_u32 m0, s95, 0
    s_add_u32 s75, s75, s92
    buffer_load_dwordx4 v20, s[28:31], s75 offen offset:0 lds
    buffer_load_dwordx4 v21, s[28:31], s75 offen offset:1024 lds
    s_add_u32 m0, s97, 0
    s_add_u32 s85, s85, 1
    buffer_load_dwordx4 v26, s[32:35], s76 offen offset:0 lds
    buffer_load_dwordx4 v27, s[32:35], s76 offen offset:1024 lds
    s_and_b32 s85, s85, 7
    s_waitcnt vmcnt(8)
    s_barrier
    s_mul_i32 s76, s85, 196608
    s_lshl_b32 s75, s85, 7
    s_add_u32 m0, s96, 32768
    s_add_u32 s76, s76, s93
    buffer_load_dwordx4 v22, s[32:35], s76 offen offset:0 lds
    buffer_load_dwordx4 v23, s[32:35], s76 offen offset:1024 lds
    buffer_load_dwordx4 v24, s[32:35], s76 offen offset:2048 lds
    buffer_load_dwordx4 v25, s[32:35], s76 offen offset:3072 lds
    s_add_u32 m0, s95, 32768
    s_add_u32 s75, s75, s92
    buffer_load_dwordx4 v20, s[28:31], s75 offen offset:0 lds
    buffer_load_dwordx4 v21, s[28:31], s75 offen offset:1024 lds
    s_add_u32 m0, s97, 32768
    s_add_u32 s85, s85, 1
    buffer_load_dwordx4 v26, s[32:35], s76 offen offset:0 lds
    buffer_load_dwordx4 v27, s[32:35], s76 offen offset:1024 lds
    s_and_b32 s85, s85, 7
    s_waitcnt vmcnt(8)
    s_barrier
    s_mul_i32 s76, s85, 196608
    s_lshl_b32 s75, s85, 7
    s_add_u32 m0, s96, 65536
    s_add_u32 s76, s76, s93
    buffer_load_dwordx4 v22, s[32:35], s76 offen offset:0 lds
    buffer_load_dwordx4 v23, s[32:35], s76 offen offset:1024 lds
    buffer_load_dwordx4 v24, s[32:35], s76 offen offset:2048 lds
    buffer_load_dwordx4 v25, s[32:35], s76 offen offset:3072 lds
    s_add_u32 m0, s95, 65536
    s_add_u32 s75, s75, s92
    buffer_load_dwordx4 v20, s[28:31], s75 offen offset:0 lds
    buffer_load_dwordx4 v21, s[28:31], s75 offen offset:1024 lds
    s_add_u32 m0, s97, 65536
    s_add_u32 s85, s85, 1
    buffer_load_dwordx4 v26, s[32:35], s76 offen offset:0 lds
    buffer_load_dwordx4 v27, s[32:35], s76 offen offset:1024 lds
    s_and_b32 s85, s85, 7
    s_waitcnt vmcnt(8)
    s_barrier
    s_mul_i32 s76, s85, 196608
    s_lshl_b32 s75, s85, 7
    s_add_u32 m0, s96, 0
    s_add_u32 s76, s76, s93
    buffer_load_dwordx4 v22, s[32:35], s76 offen offset:0 lds
    buffer_load_dwordx4 v23, s[32:35], s76 offen offset:1024 lds
    buffer_load_dwordx4 v24, s[32:35], s76 offen offset:2048 lds
    buffer_load_dwordx4 v25, s[32:35], s76 offen offset:3072 lds
    s_add_u32 m0, s95, 0
    s_add_u32 s75, s75, s92
    buffer_load_dwordx4 v20, s[28:31], s75 offen offset:0 lds
    buffer_load_dwordx4 v21, s[28:31], s75 offen offset:1024 lds
    s_add_u32 m0, s97, 0
    s_add_u32 s85, s85, 1
    buffer_load_dwordx4 v26, s[32:35], s76 offen offset:0 lds
    buffer_load_dwordx4 v27, s[32:35], s76 offen offset:1024 lds
    s_and_b32 s85, s85, 7
    buffer_load_dwordx2 v[32:33], v55, s[36:39], s79 offen sc1
    s_mov_b64 exec, s[4:5]
    buffer_load_dwordx4 v[36:39], v56, s[36:39], s7 offen offset:0 sc1
    buffer_load_dwordx4 v[40:43], v56, s[36:39], s7 offen offset:1024 sc1
    buffer_load_dwordx4 v[44:47], v56, s[36:39], s7 offen offset:2048 sc1
    buffer_load_dwordx4 v[48:51], v56, s[36:39], s7 offen offset:3072 sc1
    s_mov_b64 exec, -1
    buffer_load_dwordx2 v[52:53], v57, s[36:39], 0 offen sc1
    s_waitcnt vmcnt(14)
    s_barrier
    s_mul_i32 s76, s85, 196608
    s_lshl_b32 s75, s85, 7
    s_add_u32 m0, s96, 32768
    s_add_u32 s76, s76, s93
    buffer_load_dwordx4 v22, s[32:35], s76 offen offset:0 lds
    buffer_load_dwordx4 v23, s[32:35], s76 offen offset:1024 lds
    buffer_load_dwordx4 v24, s[32:35], s76 offen offset:2048 lds
    buffer_load_dwordx4 v25, s[32:35], s76 offen offset:3072 lds
    s_add_u32 m0, s95, 32768
    s_add_u32 s75, s75, s92
    buffer_load_dwordx4 v20, s[28:31], s75 offen offset:0 lds
    buffer_load_dwordx4 v21, s[28:31], s75 offen offset:1024 lds
    s_add_u32 m0, s97, 32768
    s_add_u32 s85, s85, 1
    buffer_load_dwordx4 v26, s[32:35], s76 offen offset:0 lds
    buffer_load_dwordx4 v27, s[32:35], s76 offen offset:1024 lds
    s_and_b32 s85, s85, 7
    s_waitcnt vmcnt(14)
    s_barrier
    buffer_load_dwordx4 v[14:17], v18, s[28:31], s27 offen
    s_mov_b32 exec_lo, 0xfffffff
    s_mov_b32 exec_hi, 0x0
    buffer_load_dword v54, v54, s[36:39], 0 offen sc1
    s_mov_b64 exec, -1
    s_mov_b32 s86, 0x8000
    s_waitcnt vmcnt(10)
    s_branch POLLC_3
POLL_1:
    s_sleep 1
    buffer_load_dwordx2 v[32:33], v55, s[36:39], s79 offen sc1
    s_mov_b64 exec, s[4:5]
    buffer_load_dwordx4 v[36:39], v56, s[36:39], s7 offen offset:0 sc1
    buffer_load_dwordx4 v[40:43], v56, s[36:39], s7 offen offset:1024 sc1
    buffer_load_dwordx4 v[44:47], v56, s[36:39], s7 offen offset:2048 sc1
    buffer_load_dwordx4 v[48:51], v56, s[36:39], s7 offen offset:3072 sc1
    s_mov_b64 exec, -1
    buffer_load_dwordx2 v[52:53], v57, s[36:39], 0 offen sc1
    s_waitcnt vmcnt(0)
POLLC_3:
    v_xor_b32 v6, s26, v32
    v_xor_b32 v7, s26, v52
    v_xor_b32 v8, s26, v39
    v_xor_b32 v9, s26, v43
    v_or3_b32 v6, v6, v8, v9
    v_xor_b32 v8, s26, v47
    v_xor_b32 v9, s26, v51
    v_or3_b32 v6, v6, v8, v9
    v_or_b32 v6, v6, v7
    v_cmp_ne_u32 vcc, 0, v6
    s_nop 0
    s_cbranch_vccz POLLD_2
    s_sub_u32 s86, s86, 1
    s_cmp_lg_u32 s86, 0
    s_cbranch_scc1 POLL_1
    v_mov_b32 v9, 7
    buffer_store_dword v9, off, s[64:67], 0
POLLD_2:
    v_cmp_ne_u32 vcc, s94, v53
    v_and_b32 v6, 0xffff0000, v33
    v_rcp_f32 v64, v6
    s_mov_b32 s76, 0x01000100
    v_perm_b32 v60, v33, v33, s76
    v_xor_b32 v60, 0x80008000, v60
    s_cmp_lg_u64 vcc, 0
    s_cselect_b32 s8, 1, 0
    v_add_f32 v36, v36, v40
    v_add_f32 v44, v44, v48
    v_add_f32 v37, v37, v41
    v_add_f32 v45, v45, v49
    v_add_f32 v38, v38, v42
    v_add_f32 v46, v46, v50
    v_add_f32 v36, v36, v44
    v_add_f32 v37, v37, v45
    v_add_f32 v38, v38, v46
    v_cvt_pk_bf16_f32 v40, v36, v36
    v_cvt_pk_bf16_f32 v41, v37, v37
    v_cvt_pk_bf16_f32 v42, v38, v38
    v_lshlrev_b32 v40, 16, v40
    v_lshlrev_b32 v41, 16, v41
    v_lshlrev_b32 v42, 16, v42
    v_sub_f32 v40, v36, v40
    v_sub_f32 v41, v37, v41
    v_sub_f32 v42, v38, v42
    v_cvt_pk_bf16_f32 v61, v36, v40
    v_cvt_pk_bf16_f32 v62, v37, v41
    v_cvt_pk_bf16_f32 v63, v38, v42
    s_mul_i32 s76, s74, 1536
    s_add_u32 s76, s76, 156672
    v_lshl_add_u32 v6, v1, 2, s76
    v_mov_b32 v65, s8
    ds_write2st64_b32 v6, v64, v65 offset0:4 offset1:5
    ds_write_b32 v6, v60
    s_cmp_ge_u32 s74, 2
    s_cbranch_scc1 L_DG_4
    ds_write2st64_b32 v6, v61, v62 offset0:1 offset1:2
    ds_write_b32 v6, v63 offset:768
    ds_write2st64_b32 v6, v61, v62 offset0:13 offset1:14
    ds_write_b32 v6, v63 offset:3840
L_DG_4:
    s_waitcnt lgkmcnt(0)
    s_waitcnt vmcnt(2)
    s_barrier
    s_mov_b64 exec, -1
    buffer_load_dwordx2 v[190:191], v189, s[36:39], s6 offen sc1
    s_mov_b64 exec, -1
    v_and_b32 v6, 1, v1
    v_lshlrev_b32 v6, 6, v6
    v_lshrrev_b32 v7, 1, v1
    v_lshl_add_u32 v6, v7, 5, v6
    s_lshl_b32 s75, s68, 9
    s_lshl_b32 s76, s74, 3
    s_add_u32 s75, s75, s76
    s_add_u32 s75, s75, 0x1000
    v_add_u32 v6, s75, v6
    s_lshl_b32 s75, s68, 3
    s_add_u32 s75, s75, s74
    s_lshl_b32 s75, s75, 3
    s_add_u32 s75, s75, s69
    s_lshl_b32 s75, s75, 3
    s_add_u32 s75, s75, 0xc00
    v_lshl_add_u32 v7, v1, 8, s75
    v_cmp_gt_u32 vcc, 4, v1
    s_nop 1
    v_cndmask_b32 v233, v7, v6, vcc
    s_barrier
    s_mov_b64 exec, -1
    s_mov_b32 s86, 0x8000
    s_waitcnt vmcnt(0)
    s_branch POLLC_7
POLL_5:
    s_sleep 1
    buffer_load_dwordx2 v[190:191], v189, s[36:39], s6 offen sc1
    s_waitcnt vmcnt(0)
POLLC_7:
    v_cmp_ne_u32 vcc, s26, v190
    s_nop 0
    s_cbranch_vccz POLLD_6
    s_sub_u32 s86, s86, 1
    s_cmp_lg_u32 s86, 0
    s_cbranch_scc1 POLL_5
    v_mov_b32 v49, 8
    buffer_store_dword v49, off, s[64:67], 0
POLLD_6:
    s_mov_b64 exec, -1
    v_lshlrev_b32 v248, 16, v14
    v_and_b32 v249, 0xffff0000, v14
    v_lshlrev_b32 v250, 16, v15
    v_and_b32 v251, 0xffff0000, v15
    v_lshlrev_b32 v252, 16, v16
    v_and_b32 v253, 0xffff0000, v16
    v_lshlrev_b32 v254, 16, v17
    v_and_b32 v255, 0xffff0000, v17
    v_lshlrev_b32 v6, 16, v191
    v_and_b32 v7, 0xffff0000, v191
    v_rcp_f32 v7, v7
    v_sub_f32 v88, v248, v6
    v_sub_f32 v89, v249, v6
    v_sub_f32 v90, v250, v6
    v_sub_f32 v91, v251, v6
    v_sub_f32 v92, v252, v6
    v_sub_f32 v93, v253, v6
    v_sub_f32 v94, v254, v6
    v_sub_f32 v95, v255, v6
    v_cvt_pk_bf16_f32 v44, v88, v89
    v_cvt_pk_bf16_f32 v45, v90, v91
    v_cvt_pk_bf16_f32 v46, v92, v93
    v_cvt_pk_bf16_f32 v47, v94, v95
    v_lshlrev_b32 v88, 16, v44
    v_and_b32 v89, 0xffff0000, v44
    v_lshlrev_b32 v90, 16, v45
    v_and_b32 v91, 0xffff0000, v45
    v_lshlrev_b32 v92, 16, v46
    v_and_b32 v93, 0xffff0000, v46
    v_lshlrev_b32 v94, 16, v47
    v_and_b32 v95, 0xffff0000, v47
    v_mul_f32 v88, v88, v7
    v_mul_f32 v89, v89, v7
    v_mul_f32 v90, v90, v7
    v_mul_f32 v91, v91, v7
    v_mul_f32 v92, v92, v7
    v_mul_f32 v93, v93, v7
    v_mul_f32 v94, v94, v7
    v_mul_f32 v95, v95, v7
    v_cvt_pk_bf16_f32 v44, v88, v89
    v_cvt_pk_bf16_f32 v45, v90, v91
    v_cvt_pk_bf16_f32 v46, v92, v93
    v_cvt_pk_bf16_f32 v47, v94, v95
    v_lshlrev_b32 v88, 16, v44
    v_and_b32 v89, 0xffff0000, v44
    v_lshlrev_b32 v90, 16, v45
    v_and_b32 v91, 0xffff0000, v45
    v_lshlrev_b32 v92, 16, v46
    v_and_b32 v93, 0xffff0000, v46
    v_lshlrev_b32 v94, 16, v47
    v_and_b32 v95, 0xffff0000, v47
    v_mul_f32 v48, 0xbfb8aa3b, v88
    v_mul_f32 v49, 0xbfb8aa3b, v89
    v_mul_f32 v50, 0xbfb8aa3b, v90
    v_mul_f32 v51, 0xbfb8aa3b, v91
    v_mul_f32 v52, 0xbfb8aa3b, v92
    v_mul_f32 v53, 0xbfb8aa3b, v93
    v_mul_f32 v54, 0xbfb8aa3b, v94
    v_mul_f32 v55, 0xbfb8aa3b, v95
    v_exp_f32 v48, v48
    v_exp_f32 v49, v49
    v_exp_f32 v50, v50
    v_exp_f32 v51, v51
    v_exp_f32 v52, v52
    v_exp_f32 v53, v53
    v_exp_f32 v54, v54
    v_exp_f32 v55, v55
    v_add_f32 v48, 1.0, v48
    v_add_f32 v49, 1.0, v49
    v_add_f32 v50, 1.0, v50
    v_add_f32 v51, 1.0, v51
    v_add_f32 v52, 1.0, v52
    v_add_f32 v53, 1.0, v53
    v_add_f32 v54, 1.0, v54
    v_add_f32 v55, 1.0, v55
    v_rcp_f32 v48, v48
    v_rcp_f32 v49, v49
    v_rcp_f32 v50, v50
    v_rcp_f32 v51, v51
    v_rcp_f32 v52, v52
    v_rcp_f32 v53, v53
    v_rcp_f32 v54, v54
    v_rcp_f32 v55, v55
    v_mul_f32 v88, v88, v48
    v_mul_f32 v89, v89, v49
    v_mul_f32 v90, v90, v50
    v_mul_f32 v91, v91, v51
    v_mul_f32 v92, v92, v52
    v_mul_f32 v93, v93, v53
    v_mul_f32 v94, v94, v54
    v_mul_f32 v95, v95, v55
    v_cvt_pk_bf16_f32 v48, v88, v89
    v_cvt_pk_bf16_f32 v49, v90, v91
    v_cvt_pk_bf16_f32 v50, v92, v93
    v_cvt_pk_bf16_f32 v51, v94, v95
    v_lshlrev_b32 v88, 16, v48
    v_and_b32 v89, 0xffff0000, v48
    v_lshlrev_b32 v90, 16, v49
    v_and_b32 v91, 0xffff0000, v49
    v_lshlrev_b32 v92, 16, v50
    v_and_b32 v93, 0xffff0000, v50
    v_lshlrev_b32 v94, 16, v51
    v_and_b32 v95, 0xffff0000, v51
    v_and_b32 v6, 27, v1
    v_cmp_eq_u32 vcc, 16, v6
    v_mov_b32 v6, s90
    s_nop 0
    v_cndmask_b32 v6, 0, v6, vcc
    v_mov_b32 v96, 0
    v_mov_b32 v28, v6
    v_mov_b32 v97, 0
    v_mov_b32 v29, v6
    v_mov_b32 v98, 0
    v_mov_b32 v30, v6
    v_mov_b32 v99, 0
    v_mov_b32 v31, v6
    v_mov_b32 v100, 0
    v_mov_b32 v32, v6
    v_mov_b32 v101, 0
    v_mov_b32 v33, v6
    v_mov_b32 v102, 0
    v_mov_b32 v34, v6
    v_mov_b32 v103, 0
    v_mov_b32 v35, v6
    v_mov_b32 v104, 0
    v_mov_b32 v36, v6
    v_mov_b32 v105, 0
    v_mov_b32 v37, v6
    v_mov_b32 v106, 0
    v_mov_b32 v38, v6
    v_mov_b32 v107, 0
    v_mov_b32 v39, v6
    v_mov_b32 v108, 0
    v_mov_b32 v40, v6
    v_mov_b32 v109, 0
    v_mov_b32 v41, v6
    v_mov_b32 v110, 0
    v_mov_b32 v42, v6
    v_mov_b32 v111, 0
    v_mov_b32 v43, v6
    v_mov_b32 v3, 0
    v_mov_b32 v186, 0
    v_lshrrev_b32 v17, 2, v1
    v_and_b32 v9, 3, v1
    v_lshlrev_b32 v8, 4, v9
    s_movk_i32 s76, 3584
    v_mad_u32_u24 v237, v17, s76, v8
    v_lshl_add_u32 v8, v17, 10, v8
    s_lshl_b32 s12, s74, 13
    v_lshlrev_b32 v9, 3, v9
    v_and_b32 v17, 3, v17
    v_lshl_add_u32 v9, v17, 6, v9
    v_lshrrev_b32 v17, 4, v1
    v_lshl_add_u32 v6, v17, 9, v9
    v_add_u32 v239, s12, v6
    v_and_b32 v17, 1, v17
    v_lshl_add_u32 v9, v17, 5, v9
    v_lshrrev_b32 v16, 5, v1
    v_lshl_add_u32 v9, v16, 8, v9
    v_add_u32 v9, s12, v9
    v_lshlrev_b32 v17, 7, v1
    s_lshr_b32 s24, s70, 2
    s_lshl_b32 s24, s24, 18
    s_lshl_b32 s76, s72, 8
    s_add_u32 s24, s24, s76
    s_and_b32 s76, s70, 3
    s_lshl_b32 s25, s76, 16
    s_lshl_b32 s76, s76, 6
    s_add_u32 s24, s24, s76
    s_mov_b64 exec, 63
    s_mov_b32 s86, 0x8000
POLL_8:
    buffer_load_dword v232, v233, s[36:39], 0 offen sc1
    s_waitcnt vmcnt(0)
    v_cmp_ne_u32 vcc, s26, v232
    s_nop 0
    s_cbranch_vccz POLLD_9
    s_sleep 1
    s_sub_u32 s86, s86, 1
    s_cmp_lg_u32 s86, 0
    s_cbranch_scc1 POLL_8
    v_mov_b32 v7, 1
    buffer_store_dword v7, off, s[64:67], 0
POLLD_9:
    s_mov_b64 exec, -1
    s_lshl_b32 s75, s68, 3
    s_add_u32 s75, s75, s74
    s_lshl_b32 s75, s75, 14
    s_add_u32 s75, s75, 0x100000
    s_add_u32 s76, s75, 0x10000
    s_lshl_b32 s92, s74, 11
    s_lshl_b32 s77, s68, 3
    s_add_u32 s77, s77, s69
    s_lshl_b32 s77, s77, 3
    s_add_u32 s77, s77, s74
    s_lshl_b32 s77, s77, 10
    s_add_u32 s77, s77, 0xa00000
    s_add_u32 s79, s77, 4096
    s_mov_b32 m0, s92
    s_nop 0
    buffer_load_dwordx4 v2, s[36:39], s75 offen offset:0 sc1 lds
    buffer_load_dwordx4 v2, s[36:39], s75 offen offset:1024 sc1 lds
    s_add_u32 m0, s92, 8192
    s_nop 0
    buffer_load_dwordx4 v2, s[36:39], s76 offen offset:0 sc1 lds
    buffer_load_dwordx4 v2, s[36:39], s76 offen offset:1024 sc1 lds
    s_mul_i32 s93, s74, 6144
    s_add_u32 m0, s93, 131072
    s_add_u32 s75, s75, 2048
    buffer_load_dwordx4 v2, s[36:39], s77 offen sc1 lds
    buffer_load_dwordx4 v[10:13], v2, s[36:39], s79 offen sc1
    s_add_u32 s76, s76, 2048
    s_add_u32 m0, s92, 16384
    s_nop 0
    buffer_load_dwordx4 v2, s[36:39], s75 offen offset:0 sc1 lds
    buffer_load_dwordx4 v2, s[36:39], s75 offen offset:1024 sc1 lds
    s_add_u32 m0, s92, 24576
    s_nop 0
    buffer_load_dwordx4 v2, s[36:39], s76 offen offset:0 sc1 lds
    buffer_load_dwordx4 v2, s[36:39], s76 offen offset:1024 sc1 lds
    s_waitcnt vmcnt(0)
    s_barrier
    s_branch L_COMMON
L_GEMM:
    s_lshl_b32 s99, s78, 3
    s_add_u32 s99, s99, s71
    s_lshl_b32 s99, s99, 2
    s_add_u32 s99, s99, s70
    s_lshl_b32 s99, s99, 1
    s_lshl_b32 s79, s99, 10
    s_waitcnt lgkmcnt(0)
    s_mov_b32 s28, s4
    s_and_b32 s29, s5, 0xffff
    s_mov_b32 s30, 0x200000
    s_mov_b32 s31, 0x20000
    s_mov_b32 s60, s12
    s_and_b32 s61, s13, 0xffff
    s_mov_b32 s62, 0x400
    s_mov_b32 s63, 0x20000
    buffer_load_dwordx4 v[244:247], v2, s[28:31], s79 offen
    buffer_load_dwordx4 v[240:243], v2, s[28:31], s79 offen offset:1024
    buffer_load_dwordx4 v[176:179], v2, s[60:63], 0 offen
    s_load_dword s26, s[24:25], 0
    s_mov_b32 s36, s24
    s_and_b32 s37, s25, 0xffff
    s_mov_b32 s38, 0x1000000
    s_mov_b32 s39, 0x20000
    s_mov_b32 s40, s8
    s_and_b32 s41, s9, 0xffff
    s_mov_b32 s42, 0x80000
    s_mov_b32 s43, 0x20000
    s_mov_b32 s44, s20
    s_and_b32 s45, s21, 0xffff
    s_mov_b32 s46, 0x200000
    s_mov_b32 s47, 0x20000
    s_mov_b32 s48, s14
    s_and_b32 s49, s15, 0xffff
    s_mov_b32 s50, 0x1c0000
    s_mov_b32 s51, 0x20000
    s_mov_b32 s52, s16
    s_and_b32 s53, s17, 0xffff
    s_mov_b32 s54, 0x1c0000
    s_mov_b32 s55, 0x20000
    s_mov_b32 s56, s18
    s_and_b32 s57, s19, 0xffff
    s_mov_b32 s58, 0x1c0000
    s_mov_b32 s59, 0x20000
    s_mov_b32 s64, s22
    s_and_b32 s65, s23, 0xffff
    s_mov_b32 s66, 0x100
    s_mov_b32 s67, 0x20000
    s_sub_u32 s75, s71, 0
    s_and_b32 s75, s75, 7
    s_mul_i32 s9, s75, 28
    s_lshr_b32 s75, s2, 3
    s_add_u32 s9, s9, s75
    s_cmp_lt_u32 s75, 28
    s_cselect_b32 s75, s9, 99
    s_cmp_lt_u32 s75, 56
    s_cselect_b32 s87, 1, 0
    s_mov_b32 s88, 0xffff
    s_mov_b32 s89, 0xffff
    s_mov_b32 s90, 0x3f803f80
    v_mov_b32 v4, v2
    v_and_b32 v6, 15, v1
    v_lshlrev_b32 v6, 4, v6
    v_lshrrev_b32 v7, 5, v1
    v_lshl_add_u32 v6, v7, 9, v6
    v_add_u32 v5, 1024, v6
    v_lshrrev_b32 v189, 4, v0
    v_lshlrev_b32 v189, 3, v189
    s_lshr_b32 s6, s27, 15
    s_lshl_b32 s6, s6, 8
    s_add_u32 s6, s6, 0x10000
    s_and_b32 s74, s70, 1
    s_lshr_b32 s73, s70, 1
    s_lshr_b32 s75, s78, 3
    s_and_b32 s76, s71, 3
    s_xor_b32 s75, s75, s76
    s_or_b32 s60, s75, s73
    v_lshrrev_b32 v110, 5, v1
    v_and_b32 v111, 31, v1
    v_bfe_u32 v6, v1, 1, 3
    v_xor_b32 v7, v6, v110
    v_lshlrev_b32 v7, 4, v7
    v_lshl_add_u32 v7, v111, 7, v7
    s_lshl_b32 s75, s73, 12
    v_add_u32 v96, s75, v7
    v_xor_b32 v97, 32, v96
    v_xor_b32 v98, 64, v96
    v_xor_b32 v99, 96, v96
    v_add_u32 v100, 0x10000, v96
    v_add_u32 v101, 0x10000, v97
    v_add_u32 v102, 0x10000, v98
    v_add_u32 v103, 0x10000, v99
    v_bfe_u32 v6, v1, 2, 2
    v_bfe_u32 v8, v1, 4, 1
    v_and_b32 v9, 3, v1
    v_lshlrev_b32 v9, 3, v9
    s_lshl_b32 s75, s74, 1
    v_xor_b32 v7, s75, v6
    v_lshl_add_u32 v7, v7, 5, v9
    v_lshl_add_u32 v7, v8, 7, v7
    v_lshl_add_u32 v7, v6, 8, v7
    v_lshl_add_u32 v7, v110, 11, v7
    v_add_u32 v104, 8192, v7
    v_xor_b32 v106, 32, v104
    v_add_u32 v105, 0x10000, v104
    v_add_u32 v107, 0x10000, v106
    v_add_u32 v7, s75, v8
    v_and_b32 v8, 2, v6
    v_xor_b32 v7, v7, v8
    v_lshl_add_u32 v7, v7, 5, v9
    v_lshl_add_u32 v7, v6, 7, v7
    v_lshl_add_u32 v7, v110, 10, v7
    v_add_u32 v108, 24576, v7
    v_add_u32 v109, 0x10000, v108
    v_mov_b32 v116, 0
    v_mov_b32 v117, 0
    v_mov_b32 v118, 0
    v_mov_b32 v119, 0
    v_mov_b32 v122, s90
    v_mov_b32 v123, s90
    v_mov_b32 v220, 0
    v_mov_b32 v221, 0
    v_mov_b32 v222, 0
    v_mov_b32 v223, 0
    v_mov_b32 v224, 0
    v_mov_b32 v225, 0
    v_mov_b32 v226, 0
    v_mov_b32 v227, 0
    v_mov_b32 v228, 0
    v_mov_b32 v229, 0
    v_mov_b32 v230, 0
    v_mov_b32 v231, 0
    v_mov_b32 v232, 0
    v_mov_b32 v233, 0
    v_mov_b32 v234, 0
    v_mov_b32 v235, 0
    s_lshl_b32 s98, s78, 1
    s_add_u32 s98, s98, s73
    s_lshl_b32 s79, s98, 8
    s_add_u32 s79, s79, 0x10000
    v_lshlrev_b32 v114, 3, v111
    v_lshlrev_b32 v115, 4, v111
    v_lshl_add_u32 v115, v110, 12, v115
    s_lshl_b32 s7, s71, 13
    s_lshl_b32 s75, s74, 9
    s_add_u32 s7, s7, s75
    s_add_u32 s7, s7, 0x700000
    s_waitcnt lgkmcnt(0)
    s_mul_i32 s26, s26, 0x9E3779B1
    s_add_u32 s26, s26, 0x7F4A7C15
    s_cmp_lg_u32 s70, 0
    s_cbranch_scc1 L_NOXID
    s_getreg_b32 s94, hwreg(HW_REG_XCC_ID, 0, 4)
    v_mov_b32 v84, s26
    v_mov_b32 v85, s94
    s_lshl_b32 s76, s71, 5
    s_add_u32 s76, s76, s78
    s_lshl_b32 s76, s76, 3
    s_add_u32 s76, s76, 0xc000
    s_mov_b64 exec, 1
    buffer_store_dwordx2 v[84:85], off, s[36:39], s76 sc1
    s_mov_b64 exec, -1
    s_waitcnt vmcnt(2)
L_NOXID:
    s_waitcnt vmcnt(1)
    v_dot2_f32_bf16 v116, v244, s90, v116
    v_dot2_f32_bf16 v118, v244, v244, v118
    v_dot2_f32_bf16 v117, v240, s90, v117
    v_dot2_f32_bf16 v119, v240, v240, v119
    v_dot2_f32_bf16 v116, v245, s90, v116
    v_dot2_f32_bf16 v118, v245, v245, v118
    v_dot2_f32_bf16 v117, v241, s90, v117
    v_dot2_f32_bf16 v119, v241, v241, v119
    v_dot2_f32_bf16 v116, v246, s90, v116
    v_dot2_f32_bf16 v118, v246, v246, v118
    v_dot2_f32_bf16 v117, v242, s90, v117
    v_dot2_f32_bf16 v119, v242, v242, v119
    v_dot2_f32_bf16 v116, v247, s90, v116
    v_dot2_f32_bf16 v118, v247, v247, v118
    v_dot2_f32_bf16 v117, v243, s90, v117
    v_dot2_f32_bf16 v119, v243, v243, v119
    v_add_f32_dpp v116, v116, v116 row_shr:1 row_mask:0xf bank_mask:0xf bound_ctrl:0
    s_nop 0
    v_add_f32_dpp v117, v117, v117 row_shr:1 row_mask:0xf bank_mask:0xf bound_ctrl:0
    v_add_f32_dpp v118, v118, v118 row_shr:1 row_mask:0xf bank_mask:0xf bound_ctrl:0
    v_add_f32_dpp v119, v119, v119 row_shr:1 row_mask:0xf bank_mask:0xf bound_ctrl:0
    v_add_f32_dpp v116, v116, v116 row_shr:2 row_mask:0xf bank_mask:0xf bound_ctrl:0
    v_add_f32_dpp v117, v117, v117 row_shr:2 row_mask:0xf bank_mask:0xf bound_ctrl:0
    v_add_f32_dpp v118, v118, v118 row_shr:2 row_mask:0xf bank_mask:0xf bound_ctrl:0
    v_add_f32_dpp v119, v119, v119 row_shr:2 row_mask:0xf bank_mask:0xf bound_ctrl:0
    v_add_f32_dpp v116, v116, v116 row_shr:4 row_mask:0xf bank_mask:0xf bound_ctrl:0
    v_add_f32_dpp v117, v117, v117 row_shr:4 row_mask:0xf bank_mask:0xf bound_ctrl:0
    v_add_f32_dpp v118, v118, v118 row_shr:4 row_mask:0xf bank_mask:0xf bound_ctrl:0
    v_add_f32_dpp v119, v119, v119 row_shr:4 row_mask:0xf bank_mask:0xf bound_ctrl:0
    v_add_f32_dpp v116, v116, v116 row_shr:8 row_mask:0xf bank_mask:0xf bound_ctrl:0
    v_add_f32_dpp v117, v117, v117 row_shr:8 row_mask:0xf bank_mask:0xf bound_ctrl:0
    v_add_f32_dpp v118, v118, v118 row_shr:8 row_mask:0xf bank_mask:0xf bound_ctrl:0
    v_add_f32_dpp v119, v119, v119 row_shr:8 row_mask:0xf bank_mask:0xf bound_ctrl:0
    v_add_f32_dpp v116, v116, v116 row_bcast:15 row_mask:0xa bank_mask:0xf
    v_add_f32_dpp v117, v117, v117 row_bcast:15 row_mask:0xa bank_mask:0xf
    v_add_f32_dpp v118, v118, v118 row_bcast:15 row_mask:0xa bank_mask:0xf
    v_add_f32_dpp v119, v119, v119 row_bcast:15 row_mask:0xa bank_mask:0xf
    v_add_f32_dpp v116, v116, v116 row_bcast:31 row_mask:0xc bank_mask:0xf
    v_add_f32_dpp v117, v117, v117 row_bcast:31 row_mask:0xc bank_mask:0xf
    v_add_f32_dpp v118, v118, v118 row_bcast:31 row_mask:0xc bank_mask:0xf
    v_add_f32_dpp v119, v119, v119 row_bcast:31 row_mask:0xc bank_mask:0xf
    v_mul_f32 v116, 0x3b000000, v116
    v_mul_f32 v117, 0x3b000000, v117
    v_mul_f32 v118, 0x3b000000, v118
    v_mul_f32 v119, 0x3b000000, v119
    v_fma_f32 v118, -v116, v116, v118
    v_fma_f32 v119, -v117, v117, v119
    v_max_f32 v118, 0, v118
    v_max_f32 v119, 0, v119
    v_cvt_pk_bf16_f32 v120, v116, v118
    v_cvt_pk_bf16_f32 v121, v117, v119
    v_and_b32 v118, 0xffff0000, v120
    v_and_b32 v119, 0xffff0000, v121
    v_add_f32 v118, 0x3727c5ac, v118
    v_add_f32 v119, 0x3727c5ac, v119
    v_cvt_pk_bf16_f32 v118, v118, v118
    v_cvt_pk_bf16_f32 v119, v119, v119
    v_lshlrev_b32 v118, 16, v118
    v_lshlrev_b32 v119, 16, v119
    v_sqrt_f32 v118, v118
    v_sqrt_f32 v119, v119
    v_cvt_pk_bf16_f32 v118, v118, v118
    v_cvt_pk_bf16_f32 v119, v119, v119
    v_lshlrev_b32 v118, 16, v118
    v_lshlrev_b32 v119, 16, v119
    v_rcp_f32 v124, v118
    v_rcp_f32 v125, v119
    v_and_b32 v120, 0xffff, v120
    v_and_b32 v121, 0xffff, v121
    v_or_b32 v120, v120, v118
    v_or_b32 v121, v121, v119
    v_lshlrev_b32 v116, 16, v120
    v_lshlrev_b32 v117, 16, v121
    v_readlane_b32 s96, v120, 63
    v_readlane_b32 s62, v116, 63
    v_readlane_b32 s4, v124, 63
    v_readlane_b32 s97, v121, 63
    v_readlane_b32 s63, v117, 63
    v_readlane_b32 s5, v125, 63
    v_mov_b32 v84, s26
    v_mov_b32 v85, s96
    v_lshlrev_b32 v86, 3, v1
    v_writelane_b32 v85, s97, 1
    s_lshl_b32 s76, s99, 3
    s_add_u32 s76, s76, 0x10000
    s_mov_b64 exec, 3
    buffer_store_dwordx2 v[84:85], v86, s[36:39], s76 offen sc1
    s_mov_b64 exec, -1
    s_mul_i32 s76, s70, 1536
    s_add_u32 s76, s76, 156672
    v_lshl_add_u32 v7, v1, 2, s76
    v_lshl_add_u32 v8, v110, 4, s76
    s_barrier
    ds_read_b128 v[20:23], v96 offset:0
    ds_read_b64_tr_b16 v[36:37], v104 offset:0
    ds_read_b64_tr_b16 v[38:39], v104 offset:1024
    ds_read_b64_tr_b16 v[52:53], v106 offset:0
    ds_read_b64_tr_b16 v[54:55], v106 offset:1024
    ds_read_b64_tr_b16 v[68:69], v108 offset:0
    ds_read_b64_tr_b16 v[70:71], v108 offset:512
    ds_read_b128 v[24:27], v97 offset:0
    ds_read_b64_tr_b16 v[40:41], v104 offset:4096
    ds_read_b64_tr_b16 v[42:43], v104 offset:5120
    ds_read_b64_tr_b16 v[56:57], v106 offset:4096
    ds_read_b64_tr_b16 v[58:59], v106 offset:5120
    ds_read_b64_tr_b16 v[72:73], v108 offset:2048
    ds_read_b64_tr_b16 v[74:75], v108 offset:2560
    s_waitcnt lgkmcnt(7)
    s_cmp_eq_u32 s60, 0
    s_cbranch_scc0 L_Q_10
    v_mfma_f32_4x4x4_16b_bf16 v[208:211], v[122:123], v[36:37], 0
    v_mfma_f32_4x4x4_16b_bf16 v[212:215], v[122:123], v[52:53], 0
    v_mfma_f32_4x4x4_16b_bf16 v[216:219], v[122:123], v[68:69], 0
    v_mfma_f32_4x4x4_16b_bf16 v[208:211], v[122:123], v[38:39], v[208:211]
    v_mfma_f32_4x4x4_16b_bf16 v[212:215], v[122:123], v[54:55], v[212:215]
    v_mfma_f32_4x4x4_16b_bf16 v[216:219], v[122:123], v[70:71], v[216:219]
L_Q_10:
    v_mfma_f32_32x32x16_bf16 v[128:143], v[36:39], v[20:23], 0
    ds_read_b128 v[28:31], v98 offset:0
    ds_read_b64_tr_b16 v[44:45], v104 offset:8192
    ds_read_b64_tr_b16 v[46:47], v104 offset:9216
    v_mfma_f32_32x32x16_bf16 v[144:159], v[52:55], v[20:23], 0
    ds_read_b64_tr_b16 v[60:61], v106 offset:8192
    ds_read_b64_tr_b16 v[62:63], v106 offset:9216
    ds_read_b64_tr_b16 v[76:77], v108 offset:4096
    v_mfma_f32_32x32x16_bf16 v[160:175], v[20:23], v[68:71], 0
    ds_read_b64_tr_b16 v[78:79], v108 offset:4608
    s_waitcnt lgkmcnt(7)
    s_cmp_eq_u32 s60, 0
    s_cbranch_scc0 L_Q_11
    v_mfma_f32_4x4x4_16b_bf16 v[208:211], v[122:123], v[40:41], v[208:211]
    v_mfma_f32_4x4x4_16b_bf16 v[212:215], v[122:123], v[56:57], v[212:215]
    v_mfma_f32_4x4x4_16b_bf16 v[216:219], v[122:123], v[72:73], v[216:219]
    v_mfma_f32_4x4x4_16b_bf16 v[208:211], v[122:123], v[42:43], v[208:211]
    v_mfma_f32_4x4x4_16b_bf16 v[212:215], v[122:123], v[58:59], v[212:215]
    v_mfma_f32_4x4x4_16b_bf16 v[216:219], v[122:123], v[74:75], v[216:219]
L_Q_11:
    v_mfma_f32_32x32x16_bf16 v[128:143], v[40:43], v[24:27], v[128:143]
    ds_read_b128 v[32:35], v99 offset:0
    ds_read_b64_tr_b16 v[48:49], v104 offset:12288
    ds_read_b64_tr_b16 v[50:51], v104 offset:13312
    v_mfma_f32_32x32x16_bf16 v[144:159], v[56:59], v[24:27], v[144:159]
    ds_read_b64_tr_b16 v[64:65], v106 offset:12288
    ds_read_b64_tr_b16 v[66:67], v106 offset:13312
    ds_read_b64_tr_b16 v[80:81], v108 offset:6144
    v_mfma_f32_32x32x16_bf16 v[160:175], v[24:27], v[72:75], v[160:175]
    ds_read_b64_tr_b16 v[82:83], v108 offset:6656
    s_waitcnt lgkmcnt(7)
    s_cmp_eq_u32 s60, 0
    s_cbranch_scc0 L_Q_12
    v_mfma_f32_4x4x4_16b_bf16 v[208:211], v[122:123], v[44:45], v[208:211]
    v_mfma_f32_4x4x4_16b_bf16 v[212:215], v[122:123], v[60:61], v[212:215]
    v_mfma_f32_4x4x4_16b_bf16 v[216:219], v[122:123], v[76:77], v[216:219]
    v_mfma_f32_4x4x4_16b_bf16 v[208:211], v[122:123], v[46:47], v[208:211]
    v_mfma_f32_4x4x4_16b_bf16 v[212:215], v[122:123], v[62:63], v[212:215]
    v_mfma_f32_4x4x4_16b_bf16 v[216:219], v[122:123], v[78:79], v[216:219]
L_Q_12:
    v_mfma_f32_32x32x16_bf16 v[128:143], v[44:47], v[28:31], v[128:143]
    v_mfma_f32_32x32x16_bf16 v[144:159], v[60:63], v[28:31], v[144:159]
    v_mfma_f32_32x32x16_bf16 v[160:175], v[28:31], v[76:79], v[160:175]
    s_waitcnt lgkmcnt(0)
    s_cmp_eq_u32 s60, 0
    s_cbranch_scc0 L_Q_13
    v_mfma_f32_4x4x4_16b_bf16 v[208:211], v[122:123], v[48:49], v[208:211]
    v_mfma_f32_4x4x4_16b_bf16 v[212:215], v[122:123], v[64:65], v[212:215]
    v_mfma_f32_4x4x4_16b_bf16 v[216:219], v[122:123], v[80:81], v[216:219]
    v_mfma_f32_4x4x4_16b_bf16 v[208:211], v[122:123], v[50:51], v[208:211]
    v_mfma_f32_4x4x4_16b_bf16 v[212:215], v[122:123], v[66:67], v[212:215]
    v_mfma_f32_4x4x4_16b_bf16 v[216:219], v[122:123], v[82:83], v[216:219]
L_Q_13:
    s_barrier
    v_mfma_f32_32x32x16_bf16 v[128:143], v[48:51], v[32:35], v[128:143]
    ds_read_b128 v[20:23], v96 offset:32768
    ds_read_b64_tr_b16 v[36:37], v104 offset:32768
    ds_read_b64_tr_b16 v[38:39], v104 offset:33792
    ds_read_b64_tr_b16 v[52:53], v106 offset:32768
    ds_read_b64_tr_b16 v[54:55], v106 offset:33792
    v_mfma_f32_32x32x16_bf16 v[144:159], v[64:67], v[32:35], v[144:159]
    ds_read_b64_tr_b16 v[68:69], v108 offset:32768
    ds_read_b64_tr_b16 v[70:71], v108 offset:33280
    ds_read_b128 v[24:27], v97 offset:32768
    ds_read_b64_tr_b16 v[40:41], v104 offset:36864
    ds_read_b64_tr_b16 v[42:43], v104 offset:37888
    v_mfma_f32_32x32x16_bf16 v[160:175], v[32:35], v[80:83], v[160:175]
    ds_read_b64_tr_b16 v[56:57], v106 offset:36864
    ds_read_b64_tr_b16 v[58:59], v106 offset:37888
    ds_read_b64_tr_b16 v[72:73], v108 offset:34816
    ds_read_b64_tr_b16 v[74:75], v108 offset:35328
    s_cmp_eq_u32 s60, 0
    s_cbranch_scc0 L_CSP_14
    s_lshl_b32 s75, s85, 10
    s_add_u32 s75, s75, s7
    s_nop 2
    v_permlane32_swap_b32 v208, v209
    v_permlane32_swap_b32 v212, v213
    v_permlane32_swap_b32 v216, v217
    v_add_f32 v208, v208, v209
    v_add_f32 v209, v212, v213
    v_add_f32 v210, v216, v217
    v_mov_b32 v211, s26
    s_mov_b32 exec_hi, 0
    buffer_store_dwordx4 v[208:211], v115, s[36:39], s75 offen sc1
    s_mov_b64 exec, -1
L_CSP_14:
    s_waitcnt lgkmcnt(7)
    v_mfma_f32_32x32x16_bf16 v[128:143], v[36:39], v[20:23], v[128:143]
    ds_read_b128 v[28:31], v98 offset:32768
    ds_read_b64_tr_b16 v[44:45], v104 offset:40960
    ds_read_b64_tr_b16 v[46:47], v104 offset:41984
    v_mfma_f32_32x32x16_bf16 v[144:159], v[52:55], v[20:23], v[144:159]
    ds_read_b64_tr_b16 v[60:61], v106 offset:40960
    ds_read_b64_tr_b16 v[62:63], v106 offset:41984
    ds_read_b64_tr_b16 v[76:77], v108 offset:36864
    v_mfma_f32_32x32x16_bf16 v[160:175], v[20:23], v[68:71], v[160:175]
    ds_read_b64_tr_b16 v[78:79], v108 offset:37376
    s_waitcnt lgkmcnt(7)
    v_mfma_f32_32x32x16_bf16 v[128:143], v[40:43], v[24:27], v[128:143]
    ds_read_b128 v[32:35], v99 offset:32768
    ds_read_b64_tr_b16 v[48:49], v104 offset:45056
    ds_read_b64_tr_b16 v[50:51], v104 offset:46080
    v_mfma_f32_32x32x16_bf16 v[144:159], v[56:59], v[24:27], v[144:159]
    ds_read_b64_tr_b16 v[64:65], v106 offset:45056
    ds_read_b64_tr_b16 v[66:67], v106 offset:46080
    ds_read_b64_tr_b16 v[80:81], v108 offset:38912
    v_mfma_f32_32x32x16_bf16 v[160:175], v[24:27], v[72:75], v[160:175]
    ds_read_b64_tr_b16 v[82:83], v108 offset:39424
    s_waitcnt lgkmcnt(7)
    v_mfma_f32_32x32x16_bf16 v[128:143], v[44:47], v[28:31], v[128:143]
    v_mfma_f32_32x32x16_bf16 v[144:159], v[60:63], v[28:31], v[144:159]
    v_mfma_f32_32x32x16_bf16 v[160:175], v[28:31], v[76:79], v[160:175]
    s_waitcnt lgkmcnt(0)
    s_barrier
    v_mfma_f32_32x32x16_bf16 v[128:143], v[48:51], v[32:35], v[128:143]
    ds_read_b128 v[20:23], v100 offset:0
    ds_read_b64_tr_b16 v[36:37], v105 offset:0
    ds_read_b64_tr_b16 v[38:39], v105 offset:1024
    ds_read_b64_tr_b16 v[52:53], v107 offset:0
    ds_read_b64_tr_b16 v[54:55], v107 offset:1024
    v_mfma_f32_32x32x16_bf16 v[144:159], v[64:67], v[32:35], v[144:159]
    ds_read_b64_tr_b16 v[68:69], v109 offset:0
    ds_read_b64_tr_b16 v[70:71], v109 offset:512
    ds_read_b128 v[24:27], v101 offset:0
    ds_read_b64_tr_b16 v[40:41], v105 offset:4096
    ds_read_b64_tr_b16 v[42:43], v105 offset:5120
    v_mfma_f32_32x32x16_bf16 v[160:175], v[32:35], v[80:83], v[160:175]
    ds_read_b64_tr_b16 v[56:57], v107 offset:4096
    ds_read_b64_tr_b16 v[58:59], v107 offset:5120
    ds_read_b64_tr_b16 v[72:73], v109 offset:2048
    ds_read_b64_tr_b16 v[74:75], v109 offset:2560
    s_waitcnt lgkmcnt(7)
    v_mfma_f32_32x32x16_bf16 v[128:143], v[36:39], v[20:23], v[128:143]
    ds_read_b128 v[28:31], v102 offset:0
    ds_read_b64_tr_b16 v[44:45], v105 offset:8192
    ds_read_b64_tr_b16 v[46:47], v105 offset:9216
    v_mfma_f32_32x32x16_bf16 v[144:159], v[52:55], v[20:23], v[144:159]
    ds_read_b64_tr_b16 v[60:61], v107 offset:8192
    ds_read_b64_tr_b16 v[62:63], v107 offset:9216
    ds_read_b64_tr_b16 v[76:77], v109 offset:4096
    v_mfma_f32_32x32x16_bf16 v[160:175], v[20:23], v[68:71], v[160:175]
    ds_read_b64_tr_b16 v[78:79], v109 offset:4608
    s_waitcnt lgkmcnt(7)
    v_mfma_f32_32x32x16_bf16 v[128:143], v[40:43], v[24:27], v[128:143]
    ds_read_b128 v[32:35], v103 offset:0
    ds_read_b64_tr_b16 v[48:49], v105 offset:12288
    ds_read_b64_tr_b16 v[50:51], v105 offset:13312
    v_mfma_f32_32x32x16_bf16 v[144:159], v[56:59], v[24:27], v[144:159]
    ds_read_b64_tr_b16 v[64:65], v107 offset:12288
    ds_read_b64_tr_b16 v[66:67], v107 offset:13312
    ds_read_b64_tr_b16 v[80:81], v109 offset:6144
    v_mfma_f32_32x32x16_bf16 v[160:175], v[24:27], v[72:75], v[160:175]
    ds_read_b64_tr_b16 v[82:83], v109 offset:6656
    s_waitcnt lgkmcnt(7)
    v_mfma_f32_32x32x16_bf16 v[128:143], v[44:47], v[28:31], v[128:143]
    v_mfma_f32_32x32x16_bf16 v[144:159], v[60:63], v[28:31], v[144:159]
    v_mfma_f32_32x32x16_bf16 v[160:175], v[28:31], v[76:79], v[160:175]
    s_waitcnt lgkmcnt(0)
    s_barrier
    v_mfma_f32_32x32x16_bf16 v[128:143], v[48:51], v[32:35], v[128:143]
    ds_read_b128 v[20:23], v96 offset:0
    ds_read_b64_tr_b16 v[36:37], v104 offset:0
    ds_read_b64_tr_b16 v[38:39], v104 offset:1024
    ds_read_b64_tr_b16 v[52:53], v106 offset:0
    ds_read_b64_tr_b16 v[54:55], v106 offset:1024
    v_mfma_f32_32x32x16_bf16 v[144:159], v[64:67], v[32:35], v[144:159]
    ds_read_b64_tr_b16 v[68:69], v108 offset:0
    ds_read_b64_tr_b16 v[70:71], v108 offset:512
    ds_read_b128 v[24:27], v97 offset:0
    ds_read_b64_tr_b16 v[40:41], v104 offset:4096
    ds_read_b64_tr_b16 v[42:43], v104 offset:5120
    v_mfma_f32_32x32x16_bf16 v[160:175], v[32:35], v[80:83], v[160:175]
    ds_read_b64_tr_b16 v[56:57], v106 offset:4096
    ds_read_b64_tr_b16 v[58:59], v106 offset:5120
    ds_read_b64_tr_b16 v[72:73], v108 offset:2048
    ds_read_b64_tr_b16 v[74:75], v108 offset:2560
    buffer_load_dwordx2 v[190:191], v189, s[36:39], s6 offen sc1
    s_waitcnt lgkmcnt(7)
    v_mfma_f32_32x32x16_bf16 v[128:143], v[36:39], v[20:23], v[128:143]
    ds_read_b128 v[28:31], v98 offset:0
    ds_read_b64_tr_b16 v[44:45], v104 offset:8192
    ds_read_b64_tr_b16 v[46:47], v104 offset:9216
    v_mfma_f32_32x32x16_bf16 v[144:159], v[52:55], v[20:23], v[144:159]
    ds_read_b64_tr_b16 v[60:61], v106 offset:8192
    ds_read_b64_tr_b16 v[62:63], v106 offset:9216
    ds_read_b64_tr_b16 v[76:77], v108 offset:4096
    v_mfma_f32_32x32x16_bf16 v[160:175], v[20:23], v[68:71], v[160:175]
    ds_read_b64_tr_b16 v[78:79], v108 offset:4608
    s_waitcnt lgkmcnt(7)
    v_mfma_f32_32x32x16_bf16 v[128:143], v[40:43], v[24:27], v[128:143]
    ds_read_b128 v[32:35], v99 offset:0
    ds_read_b64_tr_b16 v[48:49], v104 offset:12288
    ds_read_b64_tr_b16 v[50:51], v104 offset:13312
    v_mfma_f32_32x32x16_bf16 v[144:159], v[56:59], v[24:27], v[144:159]
    ds_read_b64_tr_b16 v[64:65], v106 offset:12288
    ds_read_b64_tr_b16 v[66:67], v106 offset:13312
    ds_read_b64_tr_b16 v[80:81], v108 offset:6144
    v_mfma_f32_32x32x16_bf16 v[160:175], v[24:27], v[72:75], v[160:175]
    ds_read_b64_tr_b16 v[82:83], v108 offset:6656
    s_waitcnt lgkmcnt(7)
    v_mfma_f32_32x32x16_bf16 v[128:143], v[44:47], v[28:31], v[128:143]
    v_mfma_f32_32x32x16_bf16 v[144:159], v[60:63], v[28:31], v[144:159]
    v_mfma_f32_32x32x16_bf16 v[160:175], v[28:31], v[76:79], v[160:175]
    s_waitcnt lgkmcnt(0)
    s_barrier
    v_mfma_f32_32x32x16_bf16 v[128:143], v[48:51], v[32:35], v[128:143]
    ds_read_b128 v[20:23], v96 offset:32768
    ds_read_b64_tr_b16 v[36:37], v104 offset:32768
    ds_read_b64_tr_b16 v[38:39], v104 offset:33792
    ds_read_b64_tr_b16 v[52:53], v106 offset:32768
    ds_read_b64_tr_b16 v[54:55], v106 offset:33792
    v_mfma_f32_32x32x16_bf16 v[144:159], v[64:67], v[32:35], v[144:159]
    ds_read_b64_tr_b16 v[68:69], v108 offset:32768
    ds_read_b64_tr_b16 v[70:71], v108 offset:33280
    ds_read_b128 v[24:27], v97 offset:32768
    ds_read_b64_tr_b16 v[40:41], v104 offset:36864
    ds_read_b64_tr_b16 v[42:43], v104 offset:37888
    v_mfma_f32_32x32x16_bf16 v[160:175], v[32:35], v[80:83], v[160:175]
    ds_read_b64_tr_b16 v[56:57], v106 offset:36864
    ds_read_b64_tr_b16 v[58:59], v106 offset:37888
    ds_read_b64_tr_b16 v[72:73], v108 offset:34816
    ds_read_b64_tr_b16 v[74:75], v108 offset:35328
    s_waitcnt lgkmcnt(7)
    v_mfma_f32_32x32x16_bf16 v[128:143], v[36:39], v[20:23], v[128:143]
    ds_read_b128 v[28:31], v98 offset:32768
    ds_read_b64_tr_b16 v[44:45], v104 offset:40960
    ds_read_b64_tr_b16 v[46:47], v104 offset:41984
    v_mfma_f32_32x32x16_bf16 v[144:159], v[52:55], v[20:23], v[144:159]
    ds_read_b64_tr_b16 v[60:61], v106 offset:40960
    ds_read_b64_tr_b16 v[62:63], v106 offset:41984
    ds_read_b64_tr_b16 v[76:77], v108 offset:36864
    v_mfma_f32_32x32x16_bf16 v[160:175], v[20:23], v[68:71], v[160:175]
    ds_read_b64_tr_b16 v[78:79], v108 offset:37376
    s_waitcnt lgkmcnt(7)
    v_mfma_f32_32x32x16_bf16 v[128:143], v[40:43], v[24:27], v[128:143]
    ds_read_b128 v[32:35], v99 offset:32768
    ds_read_b64_tr_b16 v[48:49], v104 offset:45056
    ds_read_b64_tr_b16 v[50:51], v104 offset:46080
    v_mfma_f32_32x32x16_bf16 v[144:159], v[56:59], v[24:27], v[144:159]
    ds_read_b64_tr_b16 v[64:65], v106 offset:45056
    ds_read_b64_tr_b16 v[66:67], v106 offset:46080
    ds_read_b64_tr_b16 v[80:81], v108 offset:38912
    v_mfma_f32_32x32x16_bf16 v[160:175], v[24:27], v[72:75], v[160:175]
    ds_read_b64_tr_b16 v[82:83], v108 offset:39424
    s_waitcnt lgkmcnt(7)
    v_mfma_f32_32x32x16_bf16 v[128:143], v[44:47], v[28:31], v[128:143]
    v_mfma_f32_32x32x16_bf16 v[144:159], v[60:63], v[28:31], v[144:159]
    v_mfma_f32_32x32x16_bf16 v[160:175], v[28:31], v[76:79], v[160:175]
    s_waitcnt lgkmcnt(0)
    s_barrier
    v_mfma_f32_32x32x16_bf16 v[128:143], v[48:51], v[32:35], v[128:143]
    ds_read_b128 v[20:23], v100 offset:0
    ds_read_b64_tr_b16 v[36:37], v105 offset:0
    ds_read_b64_tr_b16 v[38:39], v105 offset:1024
    ds_read_b64_tr_b16 v[52:53], v107 offset:0
    ds_read_b64_tr_b16 v[54:55], v107 offset:1024
    v_mfma_f32_32x32x16_bf16 v[144:159], v[64:67], v[32:35], v[144:159]
    ds_read_b64_tr_b16 v[68:69], v109 offset:0
    ds_read_b64_tr_b16 v[70:71], v109 offset:512
    ds_read_b128 v[24:27], v101 offset:0
    ds_read_b64_tr_b16 v[40:41], v105 offset:4096
    ds_read_b64_tr_b16 v[42:43], v105 offset:5120
    v_mfma_f32_32x32x16_bf16 v[160:175], v[32:35], v[80:83], v[160:175]
    ds_read_b64_tr_b16 v[56:57], v107 offset:4096
    ds_read_b64_tr_b16 v[58:59], v107 offset:5120
    ds_read_b64_tr_b16 v[72:73], v109 offset:2048
    ds_read_b64_tr_b16 v[74:75], v109 offset:2560
    s_waitcnt lgkmcnt(7)
    v_mfma_f32_32x32x16_bf16 v[128:143], v[36:39], v[20:23], v[128:143]
    ds_read_b128 v[28:31], v102 offset:0
    ds_read_b64_tr_b16 v[44:45], v105 offset:8192
    ds_read_b64_tr_b16 v[46:47], v105 offset:9216
    v_mfma_f32_32x32x16_bf16 v[144:159], v[52:55], v[20:23], v[144:159]
    ds_read_b64_tr_b16 v[60:61], v107 offset:8192
    ds_read_b64_tr_b16 v[62:63], v107 offset:9216
    ds_read_b64_tr_b16 v[76:77], v109 offset:4096
    v_mfma_f32_32x32x16_bf16 v[160:175], v[20:23], v[68:71], v[160:175]
    ds_read_b64_tr_b16 v[78:79], v109 offset:4608
    s_waitcnt lgkmcnt(7)
    v_mfma_f32_32x32x16_bf16 v[128:143], v[40:43], v[24:27], v[128:143]
    ds_read_b128 v[32:35], v103 offset:0
    ds_read_b64_tr_b16 v[48:49], v105 offset:12288
    ds_read_b64_tr_b16 v[50:51], v105 offset:13312
    v_mfma_f32_32x32x16_bf16 v[144:159], v[56:59], v[24:27], v[144:159]
    ds_read_b64_tr_b16 v[64:65], v107 offset:12288
    ds_read_b64_tr_b16 v[66:67], v107 offset:13312
    ds_read_b64_tr_b16 v[80:81], v109 offset:6144
    v_mfma_f32_32x32x16_bf16 v[160:175], v[24:27], v[72:75], v[160:175]
    ds_read_b64_tr_b16 v[82:83], v109 offset:6656
    s_waitcnt lgkmcnt(7)
    v_mfma_f32_32x32x16_bf16 v[128:143], v[44:47], v[28:31], v[128:143]
    v_mfma_f32_32x32x16_bf16 v[144:159], v[60:63], v[28:31], v[144:159]
    v_mfma_f32_32x32x16_bf16 v[160:175], v[28:31], v[76:79], v[160:175]
    s_waitcnt lgkmcnt(0)
    s_barrier
    v_mfma_f32_32x32x16_bf16 v[128:143], v[48:51], v[32:35], v[128:143]
    ds_read_b128 v[20:23], v96 offset:0
    ds_read_b64_tr_b16 v[36:37], v104 offset:0
    ds_read_b64_tr_b16 v[38:39], v104 offset:1024
    ds_read_b64_tr_b16 v[52:53], v106 offset:0
    ds_read_b64_tr_b16 v[54:55], v106 offset:1024
    v_mfma_f32_32x32x16_bf16 v[144:159], v[64:67], v[32:35], v[144:159]
    ds_read_b64_tr_b16 v[68:69], v108 offset:0
    ds_read_b64_tr_b16 v[70:71], v108 offset:512
    ds_read_b128 v[24:27], v97 offset:0
    ds_read_b64_tr_b16 v[40:41], v104 offset:4096
    ds_read_b64_tr_b16 v[42:43], v104 offset:5120
    v_mfma_f32_32x32x16_bf16 v[160:175], v[32:35], v[80:83], v[160:175]
    ds_read_b64_tr_b16 v[56:57], v106 offset:4096
    ds_read_b64_tr_b16 v[58:59], v106 offset:5120
    ds_read_b64_tr_b16 v[72:73], v108 offset:2048
    ds_read_b64_tr_b16 v[74:75], v108 offset:2560
    s_waitcnt lgkmcnt(7)
    v_mfma_f32_32x32x16_bf16 v[128:143], v[36:39], v[20:23], v[128:143]
    ds_read_b128 v[28:31], v98 offset:0
    ds_read_b64_tr_b16 v[44:45], v104 offset:8192
    ds_read_b64_tr_b16 v[46:47], v104 offset:9216
    v_mfma_f32_32x32x16_bf16 v[144:159], v[52:55], v[20:23], v[144:159]
    ds_read_b64_tr_b16 v[60:61], v106 offset:8192
    ds_read_b64_tr_b16 v[62:63], v106 offset:9216
    ds_read_b64_tr_b16 v[76:77], v108 offset:4096
    v_mfma_f32_32x32x16_bf16 v[160:175], v[20:23], v[68:71], v[160:175]
    ds_read_b64_tr_b16 v[78:79], v108 offset:4608
    s_waitcnt lgkmcnt(7)
    v_mfma_f32_32x32x16_bf16 v[128:143], v[40:43], v[24:27], v[128:143]
    ds_read_b128 v[32:35], v99 offset:0
    ds_read_b64_tr_b16 v[48:49], v104 offset:12288
    ds_read_b64_tr_b16 v[50:51], v104 offset:13312
    v_mfma_f32_32x32x16_bf16 v[144:159], v[56:59], v[24:27], v[144:159]
    ds_read_b64_tr_b16 v[64:65], v106 offset:12288
    ds_read_b64_tr_b16 v[66:67], v106 offset:13312
    ds_read_b64_tr_b16 v[80:81], v108 offset:6144
    v_mfma_f32_32x32x16_bf16 v[160:175], v[24:27], v[72:75], v[160:175]
    ds_read_b64_tr_b16 v[82:83], v108 offset:6656
    s_waitcnt lgkmcnt(7)
    v_mfma_f32_32x32x16_bf16 v[128:143], v[44:47], v[28:31], v[128:143]
    v_mfma_f32_32x32x16_bf16 v[144:159], v[60:63], v[28:31], v[144:159]
    v_mfma_f32_32x32x16_bf16 v[160:175], v[28:31], v[76:79], v[160:175]
    s_waitcnt lgkmcnt(0)
    s_barrier
    ds_read_b32 v232, v7 offset:0
    ds_read_b32 v220, v7 offset:256
    ds_read_b32 v224, v7 offset:512
    ds_read_b32 v228, v7 offset:768
    ds_read_b32 v186, v7 offset:1024
    ds_read_b32 v112, v7 offset:1280
    v_mfma_f32_32x32x16_bf16 v[128:143], v[48:51], v[32:35], v[128:143]
    ds_read_b128 v[20:23], v96 offset:32768
    ds_read_b64_tr_b16 v[36:37], v104 offset:32768
    ds_read_b64_tr_b16 v[38:39], v104 offset:33792
    v_mfma_f32_32x32x16_bf16 v[144:159], v[64:67], v[32:35], v[144:159]
    ds_read_b64_tr_b16 v[52:53], v106 offset:32768
    ds_read_b64_tr_b16 v[54:55], v106 offset:33792
    ds_read_b64_tr_b16 v[68:69], v108 offset:32768
    v_mfma_f32_32x32x16_bf16 v[160:175], v[32:35], v[80:83], v[160:175]
    ds_read_b64_tr_b16 v[70:71], v108 offset:33280
    s_waitcnt lgkmcnt(7)
    v_mfma_f32_32x32x16_bf16 v[128:143], v[220:223], v[232:235], v[128:143]
    ds_read_b128 v[24:27], v97 offset:32768
    ds_read_b64_tr_b16 v[40:41], v104 offset:36864
    ds_read_b64_tr_b16 v[42:43], v104 offset:37888
    ds_read_b64_tr_b16 v[56:57], v106 offset:36864
    v_mfma_f32_32x32x16_bf16 v[144:159], v[224:227], v[232:235], v[144:159]
    ds_read_b64_tr_b16 v[58:59], v106 offset:37888
    ds_read_b64_tr_b16 v[72:73], v108 offset:34816
    ds_read_b64_tr_b16 v[74:75], v108 offset:35328
    v_mfma_f32_32x32x16_bf16 v[160:175], v[232:235], v[228:231], v[160:175]
    v_mul_f32 v188, 0x3eb8aa3b, v186
    v_readfirstlane_b32 s8, v112
    s_waitcnt lgkmcnt(7)
    v_mfma_f32_32x32x16_bf16 v[128:143], v[36:39], v[20:23], v[128:143]
    ds_read_b128 v[28:31], v98 offset:32768
    ds_read_b64_tr_b16 v[44:45], v104 offset:40960
    ds_read_b64_tr_b16 v[46:47], v104 offset:41984
    v_mfma_f32_32x32x16_bf16 v[144:159], v[52:55], v[20:23], v[144:159]
    ds_read_b64_tr_b16 v[60:61], v106 offset:40960
    ds_read_b64_tr_b16 v[62:63], v106 offset:41984
    ds_read_b64_tr_b16 v[76:77], v108 offset:36864
    v_mfma_f32_32x32x16_bf16 v[160:175], v[20:23], v[68:71], v[160:175]
    ds_read_b64_tr_b16 v[78:79], v108 offset:37376
    s_waitcnt lgkmcnt(7)
    v_mfma_f32_32x32x16_bf16 v[128:143], v[40:43], v[24:27], v[128:143]
    ds_read_b128 v[32:35], v99 offset:32768
    ds_read_b64_tr_b16 v[48:49], v104 offset:45056
    ds_read_b64_tr_b16 v[50:51], v104 offset:46080
    v_mfma_f32_32x32x16_bf16 v[144:159], v[56:59], v[24:27], v[144:159]
    ds_read_b64_tr_b16 v[64:65], v106 offset:45056
    ds_read_b64_tr_b16 v[66:67], v106 offset:46080
    ds_read_b64_tr_b16 v[80:81], v108 offset:38912
    v_mfma_f32_32x32x16_bf16 v[160:175], v[24:27], v[72:75], v[160:175]
    ds_read_b64_tr_b16 v[82:83], v108 offset:39424
    s_waitcnt lgkmcnt(7)
    v_mfma_f32_32x32x16_bf16 v[128:143], v[44:47], v[28:31], v[128:143]
    ds_read_b128 v[192:195], v8 offset:1024
    ds_read_b128 v[196:199], v8 offset:1056
    v_mfma_f32_32x32x16_bf16 v[144:159], v[60:63], v[28:31], v[144:159]
    ds_read_b128 v[200:203], v8 offset:1088
    ds_read_b128 v[204:207], v8 offset:1120
    v_mfma_f32_32x32x16_bf16 v[160:175], v[28:31], v[76:79], v[160:175]
    s_waitcnt lgkmcnt(4)
    v_mfma_f32_32x32x16_bf16 v[128:143], v[48:51], v[32:35], v[128:143]
    s_barrier
    v_mfma_f32_32x32x16_bf16 v[144:159], v[64:67], v[32:35], v[144:159]
    buffer_load_dwordx4 v[14:17], v18, s[28:31], s27 offen
    s_lshl_b32 s75, s71, 1
    s_add_u32 s75, s75, s74
    s_lshl_b32 s75, s75, 7
    s_add_u32 s75, s75, s98
    v_mfma_f32_32x32x16_bf16 v[160:175], v[32:35], v[80:83], v[160:175]
    s_lshl_b32 s77, s75, 10
    s_add_u32 s77, s77, 0xa00000
    s_lshl_b32 s75, s75, 11
    s_add_u32 s75, s75, 0x100000
    s_add_u32 s76, s75, 0x20000
    s_add_u32 s79, s77, 0x10000
    v_bfe_u32 v8, v1, 4, 1
    v_lshlrev_b32 v8, 17, v8
    v_add_u32 v126, v8, v5
    v_pk_mul_f32 v[128:129], v[128:129], v[188:189] op_sel_hi:[1,0]
    v_pk_mul_f32 v[130:131], v[130:131], v[188:189] op_sel_hi:[1,0]
    v_pk_mul_f32 v[132:133], v[132:133], v[188:189] op_sel_hi:[1,0]
    v_pk_mul_f32 v[134:135], v[134:135], v[188:189] op_sel_hi:[1,0]
    v_cvt_pk_bf16_f32 v128, v128, v129
    v_cvt_pk_bf16_f32 v129, v130, v131
    v_cvt_pk_bf16_f32 v130, v132, v133
    v_cvt_pk_bf16_f32 v131, v134, v135
    v_pk_mul_f32 v[144:145], v[144:145], v[188:189] op_sel_hi:[1,0]
    v_pk_mul_f32 v[146:147], v[146:147], v[188:189] op_sel_hi:[1,0]
    v_pk_mul_f32 v[148:149], v[148:149], v[188:189] op_sel_hi:[1,0]
    v_pk_mul_f32 v[150:151], v[150:151], v[188:189] op_sel_hi:[1,0]
    v_cvt_pk_bf16_f32 v144, v144, v145
    v_cvt_pk_bf16_f32 v145, v146, v147
    v_cvt_pk_bf16_f32 v146, v148, v149
    v_cvt_pk_bf16_f32 v147, v150, v151
    s_cmp_lg_u32 s8, 0
    s_cbranch_scc1 L_MR_15
    buffer_store_dwordx4 v[128:131], v2, s[36:39], s77 offen
    buffer_store_dwordx4 v[144:147], v2, s[36:39], s79 offen
    s_branch L_ME_16
L_MR_15:
    buffer_store_dwordx4 v[128:131], v2, s[36:39], s77 offen sc1
    buffer_store_dwordx4 v[144:147], v2, s[36:39], s79 offen sc1
L_ME_16:
    v_pk_mul_f32 v[136:137], v[136:137], v[186:187] op_sel_hi:[1,0]
    v_pk_mul_f32 v[138:139], v[138:139], v[186:187] op_sel_hi:[1,0]
    v_pk_mul_f32 v[140:141], v[140:141], v[186:187] op_sel_hi:[1,0]
    v_pk_mul_f32 v[142:143], v[142:143], v[186:187] op_sel_hi:[1,0]
    v_cvt_pk_bf16_f32 v136, v136, v137
    v_cvt_pk_bf16_f32 v137, v138, v139
    v_cvt_pk_bf16_f32 v138, v140, v141
    v_cvt_pk_bf16_f32 v139, v142, v143
    v_pk_mul_f32 v[152:153], v[152:153], v[186:187] op_sel_hi:[1,0]
    v_pk_mul_f32 v[154:155], v[154:155], v[186:187] op_sel_hi:[1,0]
    v_pk_mul_f32 v[156:157], v[156:157], v[186:187] op_sel_hi:[1,0]
    v_pk_mul_f32 v[158:159], v[158:159], v[186:187] op_sel_hi:[1,0]
    v_cvt_pk_bf16_f32 v152, v152, v153
    v_cvt_pk_bf16_f32 v153, v154, v155
    v_cvt_pk_bf16_f32 v154, v156, v157
    v_cvt_pk_bf16_f32 v155, v158, v159
    s_cmp_lg_u32 s8, 0
    s_cbranch_scc1 L_MR_17
    buffer_store_dwordx4 v[136:139], v2, s[36:39], s75 offen
    buffer_store_dwordx4 v[152:155], v2, s[36:39], s76 offen
    s_branch L_ME_18
L_MR_17:
    buffer_store_dwordx4 v[136:139], v2, s[36:39], s75 offen sc1
    buffer_store_dwordx4 v[152:155], v2, s[36:39], s76 offen sc1
L_ME_18:
    s_waitcnt lgkmcnt(0)
    v_pk_mul_f32 v[160:161], v[160:161], v[192:193]
    v_pk_mul_f32 v[162:163], v[162:163], v[194:195]
    v_pk_mul_f32 v[164:165], v[164:165], v[196:197]
    v_pk_mul_f32 v[166:167], v[166:167], v[198:199]
    v_pk_mul_f32 v[168:169], v[168:169], v[200:201]
    v_pk_mul_f32 v[170:171], v[170:171], v[202:203]
    v_pk_mul_f32 v[172:173], v[172:173], v[204:205]
    v_pk_mul_f32 v[174:175], v[174:175], v[206:207]
    v_cvt_pk_bf16_f32 v72, v160, v161
    v_cvt_pk_bf16_f32 v73, v162, v163
    v_cvt_pk_bf16_f32 v74, v164, v165
    v_cvt_pk_bf16_f32 v75, v166, v167
    v_cvt_pk_bf16_f32 v76, v168, v169
    v_cvt_pk_bf16_f32 v77, v170, v171
    v_cvt_pk_bf16_f32 v78, v172, v173
    v_cvt_pk_bf16_f32 v79, v174, v175
    s_cmp_lg_u32 s8, 0
    s_cbranch_scc1 L_MR_19
    buffer_store_dwordx4 v[72:75], v126, s[36:39], s75 offen
    buffer_store_dwordx4 v[76:79], v126, s[36:39], s75 offen offset:256
    s_branch L_ME_20
L_MR_19:
    buffer_store_dwordx4 v[72:75], v126, s[36:39], s75 offen sc1
    buffer_store_dwordx4 v[76:79], v126, s[36:39], s75 offen offset:256 sc1
L_ME_20:
    v_mov_b32 v6, 0
    v_mov_b32 v7, 0
    v_dot2_f32_bf16 v6, v136, v136, v6
    v_dot2_f32_bf16 v7, v152, v152, v7
    v_dot2_f32_bf16 v6, v137, v137, v6
    v_dot2_f32_bf16 v7, v153, v153, v7
    v_dot2_f32_bf16 v6, v138, v138, v6
    v_dot2_f32_bf16 v7, v154, v154, v7
    v_dot2_f32_bf16 v6, v139, v139, v6
    v_dot2_f32_bf16 v7, v155, v155, v7
    v_max3_f32 v9, |v160|, |v161|, |v162|
    v_max3_f32 v9, |v163|, |v164|, v9
    v_max3_f32 v9, |v165|, |v166|, v9
    v_max3_f32 v9, |v167|, |v168|, v9
    v_max3_f32 v9, |v169|, |v170|, v9
    v_max3_f32 v9, |v171|, |v172|, v9
    v_max3_f32 v9, |v173|, |v174|, v9
    v_permlane32_swap_b32 v6, v7
    v_max_f32 v9, |v175|, v9
    v_add_f32 v6, v6, v7
    s_mov_b32 s92, 0x5d800000
    v_cmp_nge_f32 vcc, s92, v9
    v_max_u32_dpp v6, v6, v6 row_ror:8 row_mask:0xf bank_mask:0xf
    s_nop 1
    v_max_u32_dpp v6, v6, v6 row_ror:4 row_mask:0xf bank_mask:0xf
    s_nop 1
    v_max_u32_dpp v6, v6, v6 row_ror:2 row_mask:0xf bank_mask:0xf
    s_nop 1
    v_max_u32_dpp v6, v6, v6 row_ror:1 row_mask:0xf bank_mask:0xf
    v_mov_b32 v7, v6
    s_nop 1
    v_permlane16_swap_b32 v6, v7
    v_max_u32 v9, v6, v7
    s_cmp_lg_u64 vcc, 0
    s_cselect_b32 s92, 0x7f800000, 0
    v_max_u32 v9, s92, v9
    v_mov_b32 v8, s26
    s_lshl_b32 s77, s71, 1
    s_add_u32 s77, s77, s74
    s_lshl_b32 s77, s77, 4
    s_and_b32 s79, s98, 7
    s_add_u32 s77, s77, s79
    s_lshl_b32 s77, s77, 3
    s_add_u32 s77, s77, s69
    s_lshl_b32 s77, s77, 3
    s_add_u32 s77, s77, 0x1000
    v_lshlrev_b32 v127, 9, v110
    s_mov_b32 exec_lo, 1
    s_mov_b32 exec_hi, 1
    s_waitcnt vmcnt(0)
    s_cmp_lg_u32 s8, 0
    s_cbranch_scc1 L_MR_21
    buffer_store_dwordx2 v[8:9], v127, s[36:39], s77 offen
    s_branch L_ME_22
L_MR_21:
    buffer_store_dwordx2 v[8:9], v127, s[36:39], s77 offen sc1
L_ME_22:
    s_mov_b64 exec, -1
    v_mov_b32 v52, 0
    v_mov_b32 v53, 0
    v_lshlrev_b32 v160, 16, v244
    v_and_b32 v161, 0xffff0000, v244
    v_lshlrev_b32 v162, 16, v245
    v_and_b32 v163, 0xffff0000, v245
    v_lshlrev_b32 v164, 16, v246
    v_and_b32 v165, 0xffff0000, v246
    v_lshlrev_b32 v166, 16, v247
    v_and_b32 v167, 0xffff0000, v247
    v_subrev_f32 v160, s62, v160
    v_subrev_f32 v161, s62, v161
    v_subrev_f32 v162, s62, v162
    v_subrev_f32 v163, s62, v163
    v_subrev_f32 v164, s62, v164
    v_subrev_f32 v165, s62, v165
    v_subrev_f32 v166, s62, v166
    v_subrev_f32 v167, s62, v167
    v_cvt_pk_bf16_f32 v244, v160, v161
    v_cvt_pk_bf16_f32 v245, v162, v163
    v_cvt_pk_bf16_f32 v246, v164, v165
    v_cvt_pk_bf16_f32 v247, v166, v167
    v_lshlrev_b32 v160, 16, v244
    v_and_b32 v161, 0xffff0000, v244
    v_lshlrev_b32 v162, 16, v245
    v_and_b32 v163, 0xffff0000, v245
    v_lshlrev_b32 v164, 16, v246
    v_and_b32 v165, 0xffff0000, v246
    v_lshlrev_b32 v166, 16, v247
    v_and_b32 v167, 0xffff0000, v247
    v_mul_f32 v160, s4, v160
    v_mul_f32 v161, s4, v161
    v_mul_f32 v162, s4, v162
    v_mul_f32 v163, s4, v163
    v_mul_f32 v164, s4, v164
    v_mul_f32 v165, s4, v165
    v_mul_f32 v166, s4, v166
    v_mul_f32 v167, s4, v167
    v_cvt_pk_bf16_f32 v244, v160, v161
    v_cvt_pk_bf16_f32 v245, v162, v163
    v_cvt_pk_bf16_f32 v246, v164, v165
    v_cvt_pk_bf16_f32 v247, v166, v167
    v_lshlrev_b32 v168, 16, v240
    v_and_b32 v169, 0xffff0000, v240
    v_lshlrev_b32 v170, 16, v241
    v_and_b32 v171, 0xffff0000, v241
    v_lshlrev_b32 v172, 16, v242
    v_and_b32 v173, 0xffff0000, v242
    v_lshlrev_b32 v174, 16, v243
    v_and_b32 v175, 0xffff0000, v243
    v_subrev_f32 v168, s63, v168
    v_subrev_f32 v169, s63, v169
    v_subrev_f32 v170, s63, v170
    v_subrev_f32 v171, s63, v171
    v_subrev_f32 v172, s63, v172
    v_subrev_f32 v173, s63, v173
    v_subrev_f32 v174, s63, v174
    v_subrev_f32 v175, s63, v175
    v_cvt_pk_bf16_f32 v240, v168, v169
    v_cvt_pk_bf16_f32 v241, v170, v171
    v_cvt_pk_bf16_f32 v242, v172, v173
    v_cvt_pk_bf16_f32 v243, v174, v175
    v_lshlrev_b32 v168, 16, v240
    v_and_b32 v169, 0xffff0000, v240
    v_lshlrev_b32 v170, 16, v241
    v_and_b32 v171, 0xffff0000, v241
    v_lshlrev_b32 v172, 16, v242
    v_and_b32 v173, 0xffff0000, v242
    v_lshlrev_b32 v174, 16, v243
    v_and_b32 v175, 0xffff0000, v243
    v_mul_f32 v168, s5, v168
    v_mul_f32 v169, s5, v169
    v_mul_f32 v170, s5, v170
    v_mul_f32 v171, s5, v171
    v_mul_f32 v172, s5, v172
    v_mul_f32 v173, s5, v173
    v_mul_f32 v174, s5, v174
    v_mul_f32 v175, s5, v175
    v_cvt_pk_bf16_f32 v240, v168, v169
    v_cvt_pk_bf16_f32 v241, v170, v171
    v_cvt_pk_bf16_f32 v242, v172, v173
    v_cvt_pk_bf16_f32 v243, v174, v175
    v_dot2_f32_bf16 v52, v244, v176, v52
    v_dot2_f32_bf16 v53, v240, v176, v53
    v_dot2_f32_bf16 v52, v245, v177, v52
    v_dot2_f32_bf16 v53, v241, v177, v53
    v_dot2_f32_bf16 v52, v246, v178, v52
    v_dot2_f32_bf16 v53, v242, v178, v53
    v_dot2_f32_bf16 v52, v247, v179, v52
    v_dot2_f32_bf16 v53, v243, v179, v53
    s_nop 1
    v_add_f32_dpp v52, v52, v52 row_shr:1 row_mask:0xf bank_mask:0xf bound_ctrl:0
    v_add_f32_dpp v53, v53, v53 row_shr:1 row_mask:0xf bank_mask:0xf bound_ctrl:0
    s_nop 0
    v_add_f32_dpp v52, v52, v52 row_shr:2 row_mask:0xf bank_mask:0xf bound_ctrl:0
    v_add_f32_dpp v53, v53, v53 row_shr:2 row_mask:0xf bank_mask:0xf bound_ctrl:0
    s_nop 0
    v_add_f32_dpp v52, v52, v52 row_shr:4 row_mask:0xf bank_mask:0xf bound_ctrl:0
    v_add_f32_dpp v53, v53, v53 row_shr:4 row_mask:0xf bank_mask:0xf bound_ctrl:0
    s_nop 0
    v_add_f32_dpp v52, v52, v52 row_shr:8 row_mask:0xf bank_mask:0xf bound_ctrl:0
    v_add_f32_dpp v53, v53, v53 row_shr:8 row_mask:0xf bank_mask:0xf bound_ctrl:0
    s_nop 0
    v_add_f32_dpp v52, v52, v52 row_bcast:15 row_mask:0xa bank_mask:0xf
    v_add_f32_dpp v53, v53, v53 row_bcast:15 row_mask:0xa bank_mask:0xf
    s_nop 0
    v_add_f32_dpp v52, v52, v52 row_bcast:31 row_mask:0xc bank_mask:0xf
    v_add_f32_dpp v53, v53, v53 row_bcast:31 row_mask:0xc bank_mask:0xf
    v_cvt_pk_bf16_f32 v52, v52, v52
    v_cvt_pk_bf16_f32 v53, v53, v53
    v_ashrrev_i32 v54, 31, v52
    v_ashrrev_i32 v55, 31, v53
    v_or_b32 v54, 0x80000000, v54
    v_or_b32 v55, 0x80000000, v55
    v_xor_b32 v52, v52, v54
    v_xor_b32 v53, v53, v55
    v_and_b32 v52, 0xffff0000, v52
    v_and_b32 v53, 0xffff0000, v53
    v_readlane_b32 s3, v52, 63
    v_readlane_b32 s61, v53, 63
    s_sub_u32 s79, 0xffff, s99
    s_or_b32 s3, s3, s79
    s_sub_u32 s79, s79, 1
    s_or_b32 s61, s61, s79
    v_mov_b32 v6, s26
    v_mov_b32 v7, s3
    v_lshlrev_b32 v48, 3, v1
    v_writelane_b32 v7, s61, 1
    s_lshl_b32 s79, s99, 3
    s_add_u32 s79, s79, 0x14000
    s_mov_b64 exec, 3
    buffer_store_dwordx2 v[6:7], v48, s[36:39], s79 offen sc1
    s_mov_b64 exec, -1
    s_mov_b64 exec, -1
    s_mov_b32 s86, 0x8000
    s_waitcnt vmcnt(2)
    s_branch POLLC_25
POLL_23:
    s_sleep 1
    buffer_load_dwordx2 v[190:191], v189, s[36:39], s6 offen sc1
    s_waitcnt vmcnt(0)
POLLC_25:
    v_cmp_ne_u32 vcc, s26, v190
    s_nop 0
    s_cbranch_vccz POLLD_24
    s_sub_u32 s86, s86, 1
    s_cmp_lg_u32 s86, 0
    s_cbranch_scc1 POLL_23
    v_mov_b32 v49, 8
    buffer_store_dword v49, off, s[64:67], 0
POLLD_24:
    s_mov_b64 exec, -1
    v_lshlrev_b32 v248, 16, v14
    v_and_b32 v249, 0xffff0000, v14
    v_lshlrev_b32 v250, 16, v15
    v_and_b32 v251, 0xffff0000, v15
    v_lshlrev_b32 v252, 16, v16
    v_and_b32 v253, 0xffff0000, v16
    v_lshlrev_b32 v254, 16, v17
    v_and_b32 v255, 0xffff0000, v17
    v_lshlrev_b32 v6, 16, v191
    v_and_b32 v7, 0xffff0000, v191
    v_rcp_f32 v7, v7
    v_sub_f32 v88, v248, v6
    v_sub_f32 v89, v249, v6
    v_sub_f32 v90, v250, v6
    v_sub_f32 v91, v251, v6
    v_sub_f32 v92, v252, v6
    v_sub_f32 v93, v253, v6
    v_sub_f32 v94, v254, v6
    v_sub_f32 v95, v255, v6
    v_cvt_pk_bf16_f32 v44, v88, v89
    v_cvt_pk_bf16_f32 v45, v90, v91
    v_cvt_pk_bf16_f32 v46, v92, v93
    v_cvt_pk_bf16_f32 v47, v94, v95
    v_lshlrev_b32 v88, 16, v44
    v_and_b32 v89, 0xffff0000, v44
    v_lshlrev_b32 v90, 16, v45
    v_and_b32 v91, 0xffff0000, v45
    v_lshlrev_b32 v92, 16, v46
    v_and_b32 v93, 0xffff0000, v46
    v_lshlrev_b32 v94, 16, v47
    v_and_b32 v95, 0xffff0000, v47
    v_mul_f32 v88, v88, v7
    v_mul_f32 v89, v89, v7
    v_mul_f32 v90, v90, v7
    v_mul_f32 v91, v91, v7
    v_mul_f32 v92, v92, v7
    v_mul_f32 v93, v93, v7
    v_mul_f32 v94, v94, v7
    v_mul_f32 v95, v95, v7
    v_cvt_pk_bf16_f32 v44, v88, v89
    v_cvt_pk_bf16_f32 v45, v90, v91
    v_cvt_pk_bf16_f32 v46, v92, v93
    v_cvt_pk_bf16_f32 v47, v94, v95
    v_lshlrev_b32 v88, 16, v44
    v_and_b32 v89, 0xffff0000, v44
    v_lshlrev_b32 v90, 16, v45
    v_and_b32 v91, 0xffff0000, v45
    v_lshlrev_b32 v92, 16, v46
    v_and_b32 v93, 0xffff0000, v46
    v_lshlrev_b32 v94, 16, v47
    v_and_b32 v95, 0xffff0000, v47
    v_mul_f32 v48, 0xbfb8aa3b, v88
    v_mul_f32 v49, 0xbfb8aa3b, v89
    v_mul_f32 v50, 0xbfb8aa3b, v90
    v_mul_f32 v51, 0xbfb8aa3b, v91
    v_mul_f32 v52, 0xbfb8aa3b, v92
    v_mul_f32 v53, 0xbfb8aa3b, v93
    v_mul_f32 v54, 0xbfb8aa3b, v94
    v_mul_f32 v55, 0xbfb8aa3b, v95
    v_exp_f32 v48, v48
    v_exp_f32 v49, v49
    v_exp_f32 v50, v50
    v_exp_f32 v51, v51
    v_exp_f32 v52, v52
    v_exp_f32 v53, v53
    v_exp_f32 v54, v54
    v_exp_f32 v55, v55
    v_add_f32 v48, 1.0, v48
    v_add_f32 v49, 1.0, v49
    v_add_f32 v50, 1.0, v50
    v_add_f32 v51, 1.0, v51
    v_add_f32 v52, 1.0, v52
    v_add_f32 v53, 1.0, v53
    v_add_f32 v54, 1.0, v54
    v_add_f32 v55, 1.0, v55
    v_rcp_f32 v48, v48
    v_rcp_f32 v49, v49
    v_rcp_f32 v50, v50
    v_rcp_f32 v51, v51
    v_rcp_f32 v52, v52
    v_rcp_f32 v53, v53
    v_rcp_f32 v54, v54
    v_rcp_f32 v55, v55
    v_mul_f32 v88, v88, v48
    v_mul_f32 v89, v89, v49
    v_mul_f32 v90, v90, v50
    v_mul_f32 v91, v91, v51
    v_mul_f32 v92, v92, v52
    v_mul_f32 v93, v93, v53
    v_mul_f32 v94, v94, v54
    v_mul_f32 v95, v95, v55
    v_cvt_pk_bf16_f32 v48, v88, v89
    v_cvt_pk_bf16_f32 v49, v90, v91
    v_cvt_pk_bf16_f32 v50, v92, v93
    v_cvt_pk_bf16_f32 v51, v94, v95
    v_lshlrev_b32 v88, 16, v48
    v_and_b32 v89, 0xffff0000, v48
    v_lshlrev_b32 v90, 16, v49
    v_and_b32 v91, 0xffff0000, v49
    v_lshlrev_b32 v92, 16, v50
    v_and_b32 v93, 0xffff0000, v50
    v_lshlrev_b32 v94, 16, v51
    v_and_b32 v95, 0xffff0000, v51
    v_and_b32 v6, 27, v1
    v_cmp_eq_u32 vcc, 16, v6
    v_mov_b32 v6, s90
    s_nop 0
    v_cndmask_b32 v6, 0, v6, vcc
    v_mov_b32 v96, 0
    v_mov_b32 v28, v6
    v_mov_b32 v97, 0
    v_mov_b32 v29, v6
    v_mov_b32 v98, 0
    v_mov_b32 v30, v6
    v_mov_b32 v99, 0
    v_mov_b32 v31, v6
    v_mov_b32 v100, 0
    v_mov_b32 v32, v6
    v_mov_b32 v101, 0
    v_mov_b32 v33, v6
    v_mov_b32 v102, 0
    v_mov_b32 v34, v6
    v_mov_b32 v103, 0
    v_mov_b32 v35, v6
    v_mov_b32 v104, 0
    v_mov_b32 v36, v6
    v_mov_b32 v105, 0
    v_mov_b32 v37, v6
    v_mov_b32 v106, 0
    v_mov_b32 v38, v6
    v_mov_b32 v107, 0
    v_mov_b32 v39, v6
    v_mov_b32 v108, 0
    v_mov_b32 v40, v6
    v_mov_b32 v109, 0
    v_mov_b32 v41, v6
    v_mov_b32 v110, 0
    v_mov_b32 v42, v6
    v_mov_b32 v111, 0
    v_mov_b32 v43, v6
    v_mov_b32 v3, 0
    v_mov_b32 v186, 0
    v_lshrrev_b32 v17, 2, v1
    v_and_b32 v9, 3, v1
    v_lshlrev_b32 v8, 4, v9
    s_movk_i32 s76, 3584
    v_mad_u32_u24 v237, v17, s76, v8
    v_lshl_add_u32 v8, v17, 10, v8
    s_mul_i32 s12, s70, 6144
    s_add_u32 s12, s12, 131072
    v_lshlrev_b32 v9, 3, v9
    v_and_b32 v17, 3, v17
    v_lshl_add_u32 v9, v17, 6, v9
    v_lshrrev_b32 v17, 4, v1
    v_lshl_add_u32 v6, v17, 9, v9
    v_add_u32 v239, s12, v6
    v_and_b32 v17, 1, v17
    v_lshl_add_u32 v9, v17, 5, v9
    v_lshrrev_b32 v16, 5, v1
    v_lshl_add_u32 v9, v16, 8, v9
    v_add_u32 v9, s12, v9
    v_lshlrev_b32 v17, 7, v1
    s_lshr_b32 s24, s70, 2
    s_lshl_b32 s24, s24, 18
    s_lshl_b32 s76, s72, 8
    s_add_u32 s24, s24, s76
    s_and_b32 s76, s70, 3
    s_lshl_b32 s25, s76, 16
    s_lshl_b32 s76, s76, 6
    s_add_u32 s24, s24, s76
    v_and_b32 v6, 7, v1
    v_lshlrev_b32 v6, 6, v6
    v_lshrrev_b32 v7, 3, v1
    v_lshl_add_u32 v6, v7, 5, v6
    s_lshl_b32 s76, s70, 3
    v_add_u32 v186, s76, v6
    s_lshl_b32 s78, s68, 9
    s_add_u32 s78, s78, 0x1000
    s_mov_b32 exec_lo, 0xffff
    s_mov_b32 exec_hi, 0x0
    buffer_load_dwordx2 v[184:185], v186, s[36:39], s78 offen sc1
    s_mov_b64 exec, -1
    s_lshl_b32 s7, s68, 3
    s_add_u32 s7, s7, s70
    s_lshl_b32 s7, s7, 14
    s_add_u32 s7, s7, 0x100000
    s_add_u32 s1, s69, 2
    s_sub_u32 s76, s69, 4
    s_cmp_ge_u32 s1, 8
    s_cselect_b32 s1, s76, s1
    v_add_u32 v7, s12, v2
    s_barrier
    ds_read_b128 v[10:13], v7
L_COMMON:
    s_mov_b32 s14, 0
    s_mov_b32 s15, 0
    s_mov_b32 s91, 0
    s_getpc_b64 s[80:81]
L_PC0:
    s_add_u32 s80, s80, L_RUN_LOOP-L_PC0
    s_addc_u32 s81, s81, 0
    s_cmp_lt_u32 s70, 4
    s_cbranch_scc1 L_LEAD
    s_branch L_LAG
    .p2align 6
L_ATT_START:
    v_mov_b32 v6, v2
    ds_read_b128 v[20:23], v6
    ds_read_b128 v[24:27], v6 offset:2048
    s_mov_b64 exec, s[88:89]
    ds_read_b128 v[28:31], v6 offset:1024
    ds_read_b128 v[32:35], v6 offset:1280
    s_mov_b64 exec, -1
    v_mov_b32 v84, 0
    v_mov_b32 v85, 0
    v_mov_b32 v86, 0
    v_mov_b32 v78, 0
    v_mov_b32 v79, 0
    s_waitcnt lgkmcnt(3)
    v_mfma_f32_32x32x16_bf16 v[48:63], v[20:23], v[10:13], 0
    v_dot2_f32_bf16 v3, v10, v10, v3
    v_dot2_f32_bf16 v3, v11, v11, v3
    v_dot2_f32_bf16 v3, v12, v12, v3
    v_dot2_f32_bf16 v3, v13, v13, v3
    v_mov_b32 v64, 155652
    s_nop 1
    v_mov_b32 v65, v3
    s_nop 1
    v_permlane32_swap_b32 v3, v65
    v_add_f32 v3, v3, v65
    s_mov_b32 exec_hi, 0
    ds_max_u32 v64, v3
    v_mov_b32 v66, 155656
    v_mov_b32 v67, 1
    s_mov_b64 exec, 1
    ds_add_u32 v66, v67
    s_mov_b64 exec, -1
    s_waitcnt lgkmcnt(2)
    .p2align 6
L_RUN_LOOP:
    v_exp_f32 v48, v48
    v_exp_f32 v49, v49
    v_cvt_pk_bf16_f32 v87, v78, v79
    v_mfma_f32_32x32x16_bf16 v[64:79], v[24:27], v[10:13], 0
    ds_read_b128 v[20:23], v6 offset:4096
    v_exp_f32 v50, v50
    v_exp_f32 v51, v51
    v_cvt_pk_bf16_f32 v80, v48, v49
    v_exp_f32 v52, v52
    v_exp_f32 v53, v53
    v_cvt_pk_bf16_f32 v81, v50, v51
    v_mfma_f32_32x32x16_bf16 v[96:111], v[40:43], v[84:87], v[96:111]
    s_mov_b64 exec, s[88:89]
    ds_read_b128 v[36:39], v6 offset:3072
    ds_read_b128 v[40:43], v6 offset:3328
    s_mov_b64 exec, -1
    v_exp_f32 v54, v54
    v_exp_f32 v55, v55
    v_cvt_pk_bf16_f32 v82, v52, v53
    v_exp_f32 v56, v56
    v_exp_f32 v57, v57
    v_cvt_pk_bf16_f32 v83, v54, v55
    v_exp_f32 v58, v58
    v_exp_f32 v59, v59
    v_mfma_f32_32x32x16_bf16 v[96:111], v[28:31], v[80:83], v[96:111]
    s_waitcnt lgkmcnt(0)
    v_cvt_pk_bf16_f32 v84, v56, v57
    v_exp_f32 v60, v60
    v_exp_f32 v61, v61
    v_cvt_pk_bf16_f32 v85, v58, v59
    v_exp_f32 v62, v62
    v_exp_f32 v63, v63
    v_cvt_pk_bf16_f32 v86, v60, v61
    v_exp_f32 v64, v64
    v_exp_f32 v65, v65
    v_cvt_pk_bf16_f32 v87, v62, v63
    v_mfma_f32_32x32x16_bf16 v[48:63], v[20:23], v[10:13], 0
    ds_read_b128 v[24:27], v6 offset:6144
    v_exp_f32 v66, v66
    v_exp_f32 v67, v67
    v_cvt_pk_bf16_f32 v80, v64, v65
    v_exp_f32 v68, v68
    v_exp_f32 v69, v69
    v_cvt_pk_bf16_f32 v81, v66, v67
    v_mfma_f32_32x32x16_bf16 v[96:111], v[32:35], v[84:87], v[96:111]
    s_mov_b64 exec, s[88:89]
    ds_read_b128 v[28:31], v6 offset:5120
    ds_read_b128 v[32:35], v6 offset:5376
    s_mov_b64 exec, -1
    v_exp_f32 v70, v70
    v_exp_f32 v71, v71
    v_cvt_pk_bf16_f32 v82, v68, v69
    v_exp_f32 v72, v72
    v_exp_f32 v73, v73
    v_cvt_pk_bf16_f32 v83, v70, v71
    v_exp_f32 v74, v74
    v_exp_f32 v75, v75
    v_mfma_f32_32x32x16_bf16 v[96:111], v[36:39], v[80:83], v[96:111]
    s_waitcnt lgkmcnt(0)
    v_cvt_pk_bf16_f32 v84, v72, v73
    v_exp_f32 v76, v76
    v_exp_f32 v77, v77
    v_cvt_pk_bf16_f32 v85, v74, v75
    v_exp_f32 v78, v78
    v_exp_f32 v79, v79
    v_cvt_pk_bf16_f32 v86, v76, v77
    v_exp_f32 v48, v48
    v_exp_f32 v49, v49
    v_cvt_pk_bf16_f32 v87, v78, v79
    v_mfma_f32_32x32x16_bf16 v[64:79], v[24:27], v[10:13], 0
    ds_read_b128 v[20:23], v6 offset:8192
    v_exp_f32 v50, v50
    v_exp_f32 v51, v51
    v_cvt_pk_bf16_f32 v80, v48, v49
    v_exp_f32 v52, v52
    v_exp_f32 v53, v53
    v_cvt_pk_bf16_f32 v81, v50, v51
    v_mfma_f32_32x32x16_bf16 v[96:111], v[40:43], v[84:87], v[96:111]
    s_mov_b64 exec, s[88:89]
    ds_read_b128 v[36:39], v6 offset:7168
    ds_read_b128 v[40:43], v6 offset:7424
    s_mov_b64 exec, -1
    v_exp_f32 v54, v54
    v_exp_f32 v55, v55
    v_cvt_pk_bf16_f32 v82, v52, v53
    v_exp_f32 v56, v56
    v_exp_f32 v57, v57
    v_cvt_pk_bf16_f32 v83, v54, v55
    v_exp_f32 v58, v58
    v_exp_f32 v59, v59
    v_mfma_f32_32x32x16_bf16 v[96:111], v[28:31], v[80:83], v[96:111]
    s_waitcnt lgkmcnt(0)
    v_cvt_pk_bf16_f32 v84, v56, v57
    v_exp_f32 v60, v60
    v_exp_f32 v61, v61
    v_cvt_pk_bf16_f32 v85, v58, v59
    v_exp_f32 v62, v62
    v_exp_f32 v63, v63
    v_cvt_pk_bf16_f32 v86, v60, v61
    v_exp_f32 v64, v64
    v_exp_f32 v65, v65
    v_cvt_pk_bf16_f32 v87, v62, v63
    v_mfma_f32_32x32x16_bf16 v[48:63], v[20:23], v[10:13], 0
    ds_read_b128 v[24:27], v6 offset:10240
    v_exp_f32 v66, v66
    v_exp_f32 v67, v67
    v_cvt_pk_bf16_f32 v80, v64, v65
    v_exp_f32 v68, v68
    v_exp_f32 v69, v69
    v_cvt_pk_bf16_f32 v81, v66, v67
    v_mfma_f32_32x32x16_bf16 v[96:111], v[32:35], v[84:87], v[96:111]
    s_mov_b64 exec, s[88:89]
    ds_read_b128 v[28:31], v6 offset:9216
    ds_read_b128 v[32:35], v6 offset:9472
    s_mov_b64 exec, -1
    v_exp_f32 v70, v70
    v_exp_f32 v71, v71
    v_cvt_pk_bf16_f32 v82, v68, v69
    v_exp_f32 v72, v72
    v_exp_f32 v73, v73
    v_cvt_pk_bf16_f32 v83, v70, v71
    v_exp_f32 v74, v74
    v_exp_f32 v75, v75
    v_mfma_f32_32x32x16_bf16 v[96:111], v[36:39], v[80:83], v[96:111]
    s_waitcnt lgkmcnt(0)
    v_cvt_pk_bf16_f32 v84, v72, v73
    v_exp_f32 v76, v76
    v_exp_f32 v77, v77
    v_cvt_pk_bf16_f32 v85, v74, v75
    v_exp_f32 v78, v78
    v_exp_f32 v79, v79
    v_cvt_pk_bf16_f32 v86, v76, v77
    v_add_u32 v6, 0x2000, v6
    s_sub_u32 s19, s19, 1
    s_cbranch_scc0 L_RUN_LOOP
    s_setpc_b64 s[10:11]
L_RUN_EXIT:
    v_cvt_pk_bf16_f32 v87, v78, v79
    s_nop 1
    v_mfma_f32_32x32x16_bf16 v[96:111], v[40:43], v[84:87], v[96:111]
    s_waitcnt lgkmcnt(0)
L_ATT_DONE:
    s_setprio 3
    s_lshl_b32 s75, s68, 3
    s_add_u32 s75, s75, s69
    s_lshl_b32 s75, s75, 3
    s_add_u32 s75, s75, s70
    s_lshl_b32 s76, s75, 7
    s_add_u32 s76, s76, 0x720000
    s_lshl_b32 s75, s75, 10
    s_add_u32 s75, s75, 0x500000
    s_lshl_b32 s79, s69, 3
    s_add_u32 s79, s79, s71
    v_sub_u32 v3, 32, v1
    v_rcp_f32 v6, v104
    s_nop 0
    v_mul_f32 v96, v96, v6
    v_mul_f32 v97, v97, v6
    v_mul_f32 v98, v98, v6
    v_mul_f32 v99, v99, v6
    v_mul_f32 v100, v100, v6
    v_mul_f32 v101, v101, v6
    v_mul_f32 v102, v102, v6
    v_mul_f32 v103, v103, v6
    v_cvt_pk_bf16_f32 v96, v96, v97
    v_cvt_pk_bf16_f32 v97, v98, v99
    v_cvt_pk_bf16_f32 v98, v100, v101
    v_cvt_pk_bf16_f32 v99, v102, v103
    buffer_store_dwordx4 v[96:99], v2, s[36:39], s75 offen sc1
    v_lshlrev_b32 v104, 3, v1
    v_add3_u32 v6, v96, v97, v98
    v_add_u32 v6, v6, v99
    v_alignbit_b32 v6, v6, v6, v3
    v_mov_b32 v7, v6
    s_nop 1
    v_permlane32_swap_b32 v6, v7
    v_add_u32 v6, v6, v7
    v_mov_b32 v7, v6
    s_nop 1
    v_permlane16_swap_b32 v6, v7
    v_add_u32 v6, v6, v7
    s_nop 1
    v_add_u32_dpp v6, v6, v6 row_ror:8 row_mask:0xf bank_mask:0xf
    s_nop 1
    v_add_u32_dpp v6, v6, v6 row_ror:4 row_mask:0xf bank_mask:0xf
    s_nop 1
    v_add_u32_dpp v6, v6, v6 row_ror:2 row_mask:0xf bank_mask:0xf
    s_nop 1
    v_add_u32_dpp v6, v6, v6 row_ror:1 row_mask:0xf bank_mask:0xf
    v_add_u32 v6, s26, v6
    v_mov_b32 v7, s26
    s_mov_b32 exec_lo, 0xffff
    s_mov_b32 exec_hi, 0
    buffer_store_dwordx2 v[6:7], v104, s[36:39], s76 offen sc1
    s_mov_b64 exec, -1
    s_setprio 0
    s_cmp_eq_u32 s98, 0
    s_cbranch_scc1 L_NOY
    v_and_b32 v7, 31, v0
    v_lshlrev_b32 v7, 4, v7
    v_add_u32 v7, s12, v7
    s_mov_b32 s97, s98
    s_mov_b32 s86, 0x8000
    v_mov_b32 v64, s26
    s_mov_b32 s20, 0x0c0c0400
    s_mov_b32 s21, 0x04000c0c
    s_waitcnt vmcnt(2)
    s_branch L_YCHK
L_YLOOP:
    s_ff1_i32_b32 s96, s97
    s_lshl_b32 s73, s96, 11
    s_lshl_b32 s74, s72, 9
    s_add_u32 s73, s73, s74
    s_add_u32 s73, s73, 0x20000
    buffer_load_dwordx4 v[224:227], v16, s[36:39], s73 offen sc1
    s_add_u32 s73, s73, 0x40000
    buffer_load_dwordx4 v[228:231], v16, s[36:39], s73 offen sc1
    s_add_u32 s73, s73, 0x40000
    buffer_load_dwordx4 v[232:235], v16, s[36:39], s73 offen sc1
    s_add_u32 s73, s73, 0x40000
    s_cmp_ge_u32 s70, 4
    s_cselect_b32 s74, 0, 1.0
    s_cbranch_scc0 L_Y3_26
    s_sub_u32 s73, s73, 0x40000
L_Y3_26:
    buffer_load_dwordx4 v[236:239], v16, s[36:39], s73 offen sc1
    s_waitcnt vmcnt(0)
L_YCHK:
    v_perm_b32 v65, v225, v224, s20
    v_perm_b32 v66, v227, v226, s21
    v_or_b32 v65, v65, v66
    v_cmp_ne_u32 vcc, v64, v65
    v_perm_b32 v65, v229, v228, s20
    v_perm_b32 v66, v231, v230, s21
    v_or_b32 v65, v65, v66
    v_cmp_ne_u32 s[4:5], v64, v65
    s_nop 0
    s_or_b64 vcc, vcc, s[4:5]
    v_perm_b32 v65, v233, v232, s20
    v_perm_b32 v66, v235, v234, s21
    v_or_b32 v65, v65, v66
    v_cmp_ne_u32 s[4:5], v64, v65
    s_nop 0
    s_or_b64 vcc, vcc, s[4:5]
    v_perm_b32 v65, v237, v236, s20
    v_perm_b32 v66, v239, v238, s21
    v_or_b32 v65, v65, v66
    v_cmp_ne_u32 s[4:5], v64, v65
    s_nop 0
    s_or_b64 vcc, vcc, s[4:5]
    s_cbranch_vccz L_YOK
    s_sleep 2
    s_sub_u32 s86, s86, 1
    s_cmp_lg_u32 s86, 0
    s_cbranch_scc1 L_YLOOP
    v_mov_b32 v65, 5
    buffer_store_dword v65, off, s[64:67], 0
L_YOK:
    s_bitset0_b32 s97, s96
    s_lshl_b32 s73, s96, 9
    v_add_u32 v65, s73, v7
    v_add_f32 v224, v224, v228
    v_fma_f32 v232, v236, s74, v232
    v_add_f32 v225, v225, v229
    v_fma_f32 v233, v237, s74, v233
    v_add_f32 v226, v226, v230
    v_fma_f32 v234, v238, s74, v234
    v_add_f32 v227, v227, v231
    v_fma_f32 v235, v239, s74, v235
    v_add_f32 v224, v224, v232
    v_add_f32 v225, v225, v233
    v_add_f32 v226, v226, v234
    v_add_f32 v227, v227, v235
    v_mov_b32 v228, v224
    v_mov_b32 v229, v225
    v_mov_b32 v230, v226
    v_mov_b32 v231, v227
    v_permlane32_swap_b32 v224, v228
    v_permlane32_swap_b32 v225, v229
    v_permlane32_swap_b32 v226, v230
    v_permlane32_swap_b32 v227, v231
    v_add_f32 v224, v224, v228
    v_add_f32 v225, v225, v229
    v_add_f32 v226, v226, v230
    v_add_f32 v227, v227, v231
    ds_write_b128 v65, v[224:227]
    s_cmp_lg_u32 s97, 0
    s_cbranch_scc1 L_YLOOP
L_NOY:
    s_lshl_b32 s77, s70, 18
    s_lshl_b32 s78, s79, 10
    s_add_u32 s77, s77, s78
    s_add_u32 s77, s77, 0x500000
    s_lshl_b32 s75, s70, 15
    s_lshl_b32 s78, s79, 7
    s_add_u32 s75, s75, s78
    s_add_u32 s75, s75, 0x720000
    v_lshrrev_b32 v74, 4, v1
    v_lshlrev_b32 v74, 13, v74
    s_add_u32 s16, s77, 0x10000
    s_add_u32 s17, s77, 0x20000
    s_add_u32 s18, s77, 0x30000
    s_waitcnt lgkmcnt(0)
    s_barrier
    s_waitcnt vmcnt(0)
    buffer_load_dwordx4 v[20:23], v2, s[36:39], s77 offen sc1
    buffer_load_dwordx4 v[24:27], v2, s[36:39], s16 offen sc1
    buffer_load_dwordx4 v[28:31], v2, s[36:39], s17 offen sc1
    buffer_load_dwordx4 v[32:35], v2, s[36:39], s18 offen sc1
    buffer_load_dwordx2 v[72:73], v74, s[36:39], s75 offen sc1
    s_cmp_eq_u32 s98, 0
    s_cbranch_scc1 L_NOG
    v_and_b32 v7, 15, v0
    v_lshlrev_b32 v7, 5, v7
    v_lshrrev_b32 v8, 4, v0
L_GLOOP:
    s_ff1_i32_b32 s96, s98
    s_bitset0_b32 s98, s96
    v_readlane_b32 s95, v15, s96
    s_nop 0
    s_and_b32 s78, s95, 31
    s_and_b32 s95, s95, 0xffff0000
    s_lshl_b32 s76, s96, 9
    v_add_u32 v9, s76, v7
    v_cmp_eq_u32 vcc, s78, v8
    s_nop 0
    s_and_saveexec_b64 s[4:5], vcc
    s_cbranch_execz L_GSKIP
    ds_read_b128 v[96:99], v9 offset:0
    ds_read_b128 v[100:103], v9 offset:16
    ds_read_b128 v[104:107], v9 offset:8192
    ds_read_b128 v[108:111], v9 offset:8208
    ds_read_b128 v[112:115], v9 offset:16384
    ds_read_b128 v[116:119], v9 offset:16400
    ds_read_b128 v[120:123], v9 offset:24576
    ds_read_b128 v[124:127], v9 offset:24592
    v_add_u32 v9, 131072, v9
    s_waitcnt lgkmcnt(0)
    v_add_f32 v48, v96, v104
    v_add_f32 v56, v112, v120
    v_add_f32 v49, v97, v105
    v_add_f32 v57, v113, v121
    v_add_f32 v50, v98, v106
    v_add_f32 v58, v114, v122
    v_add_f32 v51, v99, v107
    v_add_f32 v59, v115, v123
    v_add_f32 v52, v100, v108
    v_add_f32 v60, v116, v124
    v_add_f32 v53, v101, v109
    v_add_f32 v61, v117, v125
    v_add_f32 v54, v102, v110
    v_add_f32 v62, v118, v126
    v_add_f32 v55, v103, v111
    v_add_f32 v63, v119, v127
    ds_read_b128 v[96:99], v9 offset:0
    ds_read_b128 v[100:103], v9 offset:16
    ds_read_b128 v[104:107], v9 offset:6144
    ds_read_b128 v[108:111], v9 offset:6160
    ds_read_b128 v[112:115], v9 offset:12288
    ds_read_b128 v[116:119], v9 offset:12304
    ds_read_b128 v[120:123], v9 offset:18432
    ds_read_b128 v[124:127], v9 offset:18448
    v_add_f32 v48, v48, v56
    v_add_f32 v49, v49, v57
    v_add_f32 v50, v50, v58
    v_add_f32 v51, v51, v59
    v_add_f32 v52, v52, v60
    v_add_f32 v53, v53, v61
    v_add_f32 v54, v54, v62
    v_add_f32 v55, v55, v63
    s_waitcnt lgkmcnt(0)
    v_add_f32 v48, v48, v96
    v_add_f32 v49, v49, v97
    v_add_f32 v50, v50, v98
    v_add_f32 v51, v51, v99
    v_add_f32 v52, v52, v100
    v_add_f32 v53, v53, v101
    v_add_f32 v54, v54, v102
    v_add_f32 v55, v55, v103
    v_add_f32 v48, v48, v104
    v_add_f32 v49, v49, v105
    v_add_f32 v50, v50, v106
    v_add_f32 v51, v51, v107
    v_add_f32 v52, v52, v108
    v_add_f32 v53, v53, v109
    v_add_f32 v54, v54, v110
    v_add_f32 v55, v55, v111
    v_add_f32 v48, v48, v112
    v_add_f32 v49, v49, v113
    v_add_f32 v50, v50, v114
    v_add_f32 v51, v51, v115
    v_add_f32 v52, v52, v116
    v_add_f32 v53, v53, v117
    v_add_f32 v54, v54, v118
    v_add_f32 v55, v55, v119
    v_add_f32 v48, v48, v120
    v_add_f32 v49, v49, v121
    v_add_f32 v50, v50, v122
    v_add_f32 v51, v51, v123
    v_add_f32 v52, v52, v124
    v_add_f32 v53, v53, v125
    v_add_f32 v54, v54, v126
    v_add_f32 v55, v55, v127
    v_cvt_pk_bf16_f32 v56, v48, v49
    v_cvt_pk_bf16_f32 v57, v50, v51
    v_cvt_pk_bf16_f32 v58, v52, v53
    v_cvt_pk_bf16_f32 v59, v54, v55
    v_lshlrev_b32 v48, 16, v56
    v_and_b32 v49, 0xffff0000, v56
    v_lshlrev_b32 v50, 16, v57
    v_and_b32 v51, 0xffff0000, v57
    v_lshlrev_b32 v52, 16, v58
    v_and_b32 v53, 0xffff0000, v58
    v_lshlrev_b32 v54, 16, v59
    v_and_b32 v55, 0xffff0000, v59
    v_mul_f32 v48, s95, v48
    v_mul_f32 v49, s95, v49
    v_mul_f32 v50, s95, v50
    v_mul_f32 v51, s95, v51
    v_mul_f32 v52, s95, v52
    v_mul_f32 v53, s95, v53
    v_mul_f32 v54, s95, v54
    v_mul_f32 v55, s95, v55
    v_cvt_pk_bf16_f32 v56, v48, v49
    v_cvt_pk_bf16_f32 v57, v50, v51
    v_cvt_pk_bf16_f32 v58, v52, v53
    v_cvt_pk_bf16_f32 v59, v54, v55
    v_lshlrev_b32 v48, 16, v56
    v_and_b32 v49, 0xffff0000, v56
    v_lshlrev_b32 v50, 16, v57
    v_and_b32 v51, 0xffff0000, v57
    v_lshlrev_b32 v52, 16, v58
    v_and_b32 v53, 0xffff0000, v58
    v_lshlrev_b32 v54, 16, v59
    v_and_b32 v55, 0xffff0000, v59
    v_lshlrev_b32 v88, 16, v44
    v_and_b32 v89, 0xffff0000, v44
    v_lshlrev_b32 v90, 16, v45
    v_and_b32 v91, 0xffff0000, v45
    v_lshlrev_b32 v92, 16, v46
    v_and_b32 v93, 0xffff0000, v46
    v_lshlrev_b32 v94, 16, v47
    v_and_b32 v95, 0xffff0000, v47
    v_add_f32 v88, v88, v48
    v_add_f32 v89, v89, v49
    v_add_f32 v90, v90, v50
    v_add_f32 v91, v91, v51
    v_add_f32 v92, v92, v52
    v_add_f32 v93, v93, v53
    v_add_f32 v94, v94, v54
    v_add_f32 v95, v95, v55
    v_cvt_pk_bf16_f32 v56, v88, v89
    v_cvt_pk_bf16_f32 v57, v90, v91
    v_cvt_pk_bf16_f32 v58, v92, v93
    v_cvt_pk_bf16_f32 v59, v94, v95
    v_lshlrev_b32 v88, 16, v56
    v_and_b32 v89, 0xffff0000, v56
    v_lshlrev_b32 v90, 16, v57
    v_and_b32 v91, 0xffff0000, v57
    v_lshlrev_b32 v92, 16, v58
    v_and_b32 v93, 0xffff0000, v58
    v_lshlrev_b32 v94, 16, v59
    v_and_b32 v95, 0xffff0000, v59
    v_mul_f32 v48, 0xbfb8aa3b, v88
    v_mul_f32 v49, 0xbfb8aa3b, v89
    v_mul_f32 v50, 0xbfb8aa3b, v90
    v_mul_f32 v51, 0xbfb8aa3b, v91
    v_mul_f32 v52, 0xbfb8aa3b, v92
    v_mul_f32 v53, 0xbfb8aa3b, v93
    v_mul_f32 v54, 0xbfb8aa3b, v94
    v_mul_f32 v55, 0xbfb8aa3b, v95
    v_exp_f32 v48, v48
    v_exp_f32 v49, v49
    v_exp_f32 v50, v50
    v_exp_f32 v51, v51
    v_exp_f32 v52, v52
    v_exp_f32 v53, v53
    v_exp_f32 v54, v54
    v_exp_f32 v55, v55
    v_add_f32 v48, 1.0, v48
    v_add_f32 v49, 1.0, v49
    v_add_f32 v50, 1.0, v50
    v_add_f32 v51, 1.0, v51
    v_add_f32 v52, 1.0, v52
    v_add_f32 v53, 1.0, v53
    v_add_f32 v54, 1.0, v54
    v_add_f32 v55, 1.0, v55
    v_rcp_f32 v48, v48
    v_rcp_f32 v49, v49
    v_rcp_f32 v50, v50
    v_rcp_f32 v51, v51
    v_rcp_f32 v52, v52
    v_rcp_f32 v53, v53
    v_rcp_f32 v54, v54
    v_rcp_f32 v55, v55
    v_mul_f32 v88, v88, v48
    v_mul_f32 v89, v89, v49
    v_mul_f32 v90, v90, v50
    v_mul_f32 v91, v91, v51
    v_mul_f32 v92, v92, v52
    v_mul_f32 v93, v93, v53
    v_mul_f32 v94, v94, v54
    v_mul_f32 v95, v95, v55
    v_cvt_pk_bf16_f32 v48, v88, v89
    v_cvt_pk_bf16_f32 v49, v90, v91
    v_cvt_pk_bf16_f32 v50, v92, v93
    v_cvt_pk_bf16_f32 v51, v94, v95
    v_lshlrev_b32 v88, 16, v48
    v_and_b32 v89, 0xffff0000, v48
    v_lshlrev_b32 v90, 16, v49
    v_and_b32 v91, 0xffff0000, v49
    v_lshlrev_b32 v92, 16, v50
    v_and_b32 v93, 0xffff0000, v50
    v_lshlrev_b32 v94, 16, v51
    v_and_b32 v95, 0xffff0000, v51
L_GSKIP:
    s_mov_b64 exec, -1
    s_cmp_lg_u32 s98, 0
    s_cbranch_scc1 L_GLOOP
L_NOG:
    s_lshl_b32 s76, s70, 12
    s_add_u32 s76, s76, 32768
    v_add_u32 v6, s76, v2
    s_mov_b32 s86, 0x8000
POLL_27:
    s_waitcnt vmcnt(0)
    ds_write_b128 v6, v[20:23] offset:0
    v_add3_u32 v76, v20, v21, v22
    v_add_u32 v76, v76, v23
    v_alignbit_b32 v76, v76, v76, v3
    ds_write_b128 v6, v[24:27] offset:1024
    v_add3_u32 v77, v24, v25, v26
    v_add_u32 v77, v77, v27
    v_alignbit_b32 v77, v77, v77, v3
    ds_write_b128 v6, v[28:31] offset:2048
    v_add3_u32 v78, v28, v29, v30
    v_add_u32 v78, v78, v31
    v_alignbit_b32 v78, v78, v78, v3
    ds_write_b128 v6, v[32:35] offset:3072
    v_add3_u32 v79, v32, v33, v34
    v_add_u32 v79, v79, v35
    v_alignbit_b32 v79, v79, v79, v3
    v_permlane32_swap_b32 v76, v78
    s_nop 0
    v_permlane32_swap_b32 v77, v79
    v_add_u32 v76, v76, v78
    v_add_u32 v77, v77, v79
    s_nop 1
    v_permlane16_swap_b32 v76, v77
    v_add_u32 v76, v76, v77
    s_nop 1
    v_add_u32_dpp v76, v76, v76 row_ror:8 row_mask:0xf bank_mask:0xf
    s_nop 1
    v_add_u32_dpp v76, v76, v76 row_ror:4 row_mask:0xf bank_mask:0xf
    s_nop 1
    v_add_u32_dpp v76, v76, v76 row_ror:2 row_mask:0xf bank_mask:0xf
    s_nop 1
    v_add_u32_dpp v76, v76, v76 row_ror:1 row_mask:0xf bank_mask:0xf
    v_add_u32 v76, s26, v76
    v_cmp_ne_u32 vcc, v76, v72
    s_nop 0
    s_cbranch_vccz POLLD_28
    s_sub_u32 s86, s86, 1
    s_cmp_eq_u32 s86, 0
    s_cbranch_scc1 POLLT_30
    s_sleep 0
    s_bitcmp1_b32 vcc_lo, 0
    s_cbranch_scc0 L_OR_31
    buffer_load_dwordx4 v[20:23], v2, s[36:39], s77 offen sc1
L_OR_31:
    s_bitcmp1_b32 vcc_lo, 16
    s_cbranch_scc0 L_OR_32
    buffer_load_dwordx4 v[24:27], v2, s[36:39], s16 offen sc1
L_OR_32:
    s_bitcmp1_b32 vcc_hi, 0
    s_cbranch_scc0 L_OR_33
    buffer_load_dwordx4 v[28:31], v2, s[36:39], s17 offen sc1
L_OR_33:
    s_bitcmp1_b32 vcc_hi, 16
    s_cbranch_scc0 L_OR_34
    buffer_load_dwordx4 v[32:35], v2, s[36:39], s18 offen sc1
L_OR_34:
    buffer_load_dwordx2 v[72:73], v74, s[36:39], s75 offen sc1
    s_branch POLL_27
POLLT_30:
    v_mov_b32 v7, 4
    buffer_store_dword v7, off, s[64:67], 0
POLLD_28:
    v_mfma_f32_32x32x16_bf16 v[96:111], v[128:131], v[20:23], 0
    s_lshr_b32 s77, s70, 2
    s_lshl_b32 s77, s77, 14
    s_add_u32 s77, s77, 32768
    v_mfma_f32_32x32x16_bf16 v[96:111], v[132:135], v[24:27], v[96:111]
    s_add_u32 s76, s70, 1
    s_and_b32 s76, s76, 3
    s_lshl_b32 s76, s76, 12
    s_add_u32 s76, s76, s77
    v_add_u32 v36, s76, v2
    s_add_u32 s76, s70, 2
    s_and_b32 s76, s76, 3
    s_lshl_b32 s76, s76, 12
    s_add_u32 s76, s76, s77
    v_add_u32 v37, s76, v2
    s_add_u32 s76, s70, 3
    s_and_b32 s76, s76, 3
    s_lshl_b32 s76, s76, 12
    s_add_u32 s76, s76, s77
    v_add_u32 v38, s76, v2
    v_mfma_f32_32x32x16_bf16 v[96:111], v[136:139], v[28:31], v[96:111]
    v_and_b32 v6, 31, v1
    v_mul_u32_u24 v6, 528, v6
    v_lshrrev_b32 v7, 5, v1
    v_lshl_add_u32 v6, v7, 4, v6
    s_lshr_b32 s77, s70, 2
    s_mul_i32 s77, s77, 16896
    s_and_b32 s78, s70, 3
    s_lshl_b32 s78, s78, 7
    s_add_u32 s77, s77, s78
    s_add_u32 s77, s77, 65536
    v_add_u32 v6, s77, v6
    v_lshrrev_b32 v7, 4, v0
    v_mul_u32_u24 v7, 528, v7
    v_and_b32 v8, 15, v0
    v_lshl_add_u32 v7, v8, 5, v7
    v_add_u32 v7, 65536, v7
    s_waitcnt lgkmcnt(0)
    v_mfma_f32_32x32x16_bf16 v[96:111], v[140:143], v[32:35], v[96:111]
    s_barrier
    ds_read_b128 v[192:195], v36 offset:0
    ds_read_b128 v[196:199], v36 offset:1024
    ds_read_b128 v[200:203], v36 offset:2048
    ds_read_b128 v[204:207], v36 offset:3072
    ds_read_b128 v[208:211], v37 offset:0
    ds_read_b128 v[212:215], v37 offset:1024
    ds_read_b128 v[216:219], v37 offset:2048
    ds_read_b128 v[220:223], v37 offset:3072
    ds_read_b128 v[224:227], v38 offset:0
    ds_read_b128 v[228:231], v38 offset:1024
    ds_read_b128 v[232:235], v38 offset:2048
    ds_read_b128 v[236:239], v38 offset:3072
    s_or_b32 s77, s2, s70
    s_cmp_lg_u32 s77, 0
    s_cbranch_scc1 L_NON
    v_mov_b32 v8, s26
    s_mov_b64 exec, 1
    buffer_store_dword v8, off, s[36:39], 0
    s_mov_b64 exec, -1
L_NON:
    s_waitcnt lgkmcnt(11)
    v_mfma_f32_32x32x16_bf16 v[96:111], v[144:147], v[192:195], v[96:111]
    s_waitcnt lgkmcnt(10)
    v_mfma_f32_32x32x16_bf16 v[96:111], v[148:151], v[196:199], v[96:111]
    s_waitcnt lgkmcnt(9)
    v_mfma_f32_32x32x16_bf16 v[96:111], v[152:155], v[200:203], v[96:111]
    s_waitcnt lgkmcnt(8)
    v_mfma_f32_32x32x16_bf16 v[96:111], v[156:159], v[204:207], v[96:111]
    s_waitcnt lgkmcnt(7)
    v_mfma_f32_32x32x16_bf16 v[96:111], v[160:163], v[208:211], v[96:111]
    s_waitcnt lgkmcnt(6)
    v_mfma_f32_32x32x16_bf16 v[96:111], v[164:167], v[212:215], v[96:111]
    s_waitcnt lgkmcnt(5)
    v_mfma_f32_32x32x16_bf16 v[96:111], v[168:171], v[216:219], v[96:111]
    s_waitcnt lgkmcnt(4)
    v_mfma_f32_32x32x16_bf16 v[96:111], v[172:175], v[220:223], v[96:111]
    s_waitcnt lgkmcnt(3)
    v_mfma_f32_32x32x16_bf16 v[96:111], v[176:179], v[224:227], v[96:111]
    s_waitcnt lgkmcnt(2)
    v_mfma_f32_32x32x16_bf16 v[96:111], v[180:183], v[228:231], v[96:111]
    s_waitcnt lgkmcnt(1)
    v_mfma_f32_32x32x16_bf16 v[96:111], v[184:187], v[232:235], v[96:111]
    s_waitcnt lgkmcnt(0)
    v_mfma_f32_32x32x16_bf16 v[96:111], v[188:191], v[236:239], v[96:111]
    s_nop 7
    s_nop 3
    ds_write_b128 v6, v[96:99] offset:0
    ds_write_b128 v6, v[100:103] offset:32
    ds_write_b128 v6, v[104:107] offset:64
    ds_write_b128 v6, v[108:111] offset:96
    s_waitcnt lgkmcnt(0)
    s_barrier
    ds_read_b128 v[48:51], v7
    ds_read_b128 v[52:55], v7 offset:16
    ds_read_b128 v[56:59], v7 offset:16896
    ds_read_b128 v[60:63], v7 offset:16912
    s_waitcnt lgkmcnt(0)
    v_add_f32 v48, v48, v56
    v_add_f32 v49, v49, v57
    v_add_f32 v50, v50, v58
    v_add_f32 v51, v51, v59
    v_add_f32 v52, v52, v60
    v_add_f32 v53, v53, v61
    v_add_f32 v54, v54, v62
    v_add_f32 v55, v55, v63
    v_fma_f32 v48, v48, v88, v248
    v_fma_f32 v49, v49, v89, v249
    v_fma_f32 v50, v50, v90, v250
    v_fma_f32 v51, v51, v91, v251
    v_fma_f32 v52, v52, v92, v252
    v_fma_f32 v53, v53, v93, v253
    v_fma_f32 v54, v54, v94, v254
    v_fma_f32 v55, v55, v95, v255
    v_cvt_pk_bf16_f32 v56, v48, v49
    v_cvt_pk_bf16_f32 v57, v50, v51
    v_cvt_pk_bf16_f32 v58, v52, v53
    v_cvt_pk_bf16_f32 v59, v54, v55
    buffer_store_dwordx4 v[56:59], v18, s[44:47], s27 offen sc1
L_END:
    s_endpgm
L_FALLBACK:
    s_waitcnt lgkmcnt(0)
    v_mov_b32 v6, 0xff800000
    v_mov_b32 v7, v2
    s_mov_b32 s82, 64
L_MAXP:
    ds_read_b128 v[20:23], v7
    v_add_u32 v7, 2048, v7
    s_waitcnt lgkmcnt(0)
    v_mfma_f32_32x32x16_bf16 v[48:63], v[20:23], v[10:13], 0
    s_nop 11
    v_max3_f32 v6, v48, v49, v6
    v_max3_f32 v6, v50, v51, v6
    v_max3_f32 v6, v52, v53, v6
    v_max3_f32 v6, v54, v55, v6
    v_max3_f32 v6, v56, v57, v6
    v_max3_f32 v6, v58, v59, v6
    v_max3_f32 v6, v60, v61, v6
    v_max3_f32 v6, v62, v63, v6
    s_sub_u32 s82, s82, 1
    s_cmp_lg_u32 s82, 0
    s_cbranch_scc1 L_MAXP
    v_mov_b32 v7, v6
    s_nop 1
    v_permlane32_swap_b32 v6, v7
    v_max_f32 v6, v6, v7
    v_sub_f32 v112, 0, v6
    v_mov_b32 v96, 0
    v_sub_f32 v113, 0, v6
    v_mov_b32 v97, 0
    v_sub_f32 v114, 0, v6
    v_mov_b32 v98, 0
    v_sub_f32 v115, 0, v6
    v_mov_b32 v99, 0
    v_sub_f32 v116, 0, v6
    v_mov_b32 v100, 0
    v_sub_f32 v117, 0, v6
    v_mov_b32 v101, 0
    v_sub_f32 v118, 0, v6
    v_mov_b32 v102, 0
    v_sub_f32 v119, 0, v6
    v_mov_b32 v103, 0
    v_sub_f32 v120, 0, v6
    v_mov_b32 v104, 0
    v_sub_f32 v121, 0, v6
    v_mov_b32 v105, 0
    v_sub_f32 v122, 0, v6
    v_mov_b32 v106, 0
    v_sub_f32 v123, 0, v6
    v_mov_b32 v107, 0
    v_sub_f32 v124, 0, v6
    v_mov_b32 v108, 0
    v_sub_f32 v125, 0, v6
    v_mov_b32 v109, 0
    v_sub_f32 v126, 0, v6
    v_mov_b32 v110, 0
    v_sub_f32 v127, 0, v6
    v_mov_b32 v111, 0
    s_mov_b32 s19, 15
    s_call_b64 s[10:11], L_ATT_START_X
    v_cvt_pk_bf16_f32 v87, v78, v79
    s_nop 1
    v_mfma_f32_32x32x16_bf16 v[96:111], v[40:43], v[84:87], v[96:111]
    s_waitcnt lgkmcnt(0)
    s_barrier
    s_mov_b32 s91, 1
    s_getpc_b64 s[80:81]
L_PC2:
    s_add_u32 s80, s80, L_FB_RESUME-L_PC2
    s_addc_u32 s81, s81, 0
    s_setpc_b64 s[84:85]
L_FB_RESUME:
    s_waitcnt lgkmcnt(0)
    s_setpc_b64 s[10:11]
    .p2align 6
L_ATT_START_X:
    v_mov_b32 v6, v2
    ds_read_b128 v[20:23], v6
    ds_read_b128 v[24:27], v6 offset:2048
    s_mov_b64 exec, s[88:89]
    ds_read_b128 v[28:31], v6 offset:1024
    ds_read_b128 v[32:35], v6 offset:1280
    s_mov_b64 exec, -1
    v_mov_b32 v84, 0
    v_mov_b32 v85, 0
    v_mov_b32 v86, 0
    v_mov_b32 v78, 0
    v_mov_b32 v79, 0
    s_waitcnt lgkmcnt(3)
    v_mfma_f32_32x32x16_bf16 v[48:63], v[20:23], v[10:13], v[112:127]
    s_waitcnt lgkmcnt(0)
    s_nop 10
    .p2align 6
L_RUN_LOOP_X:
    v_exp_f32 v48, v48
    v_exp_f32 v49, v49
    v_cvt_pk_bf16_f32 v87, v78, v79
    v_mfma_f32_32x32x16_bf16 v[64:79], v[24:27], v[10:13], v[112:127]
    ds_read_b128 v[20:23], v6 offset:4096
    v_exp_f32 v50, v50
    v_exp_f32 v51, v51
    v_cvt_pk_bf16_f32 v80, v48, v49
    v_exp_f32 v52, v52
    v_exp_f32 v53, v53
    v_cvt_pk_bf16_f32 v81, v50, v51
    v_mfma_f32_32x32x16_bf16 v[96:111], v[40:43], v[84:87], v[96:111]
    s_mov_b64 exec, s[88:89]
    ds_read_b128 v[36:39], v6 offset:3072
    ds_read_b128 v[40:43], v6 offset:3328
    s_mov_b64 exec, -1
    v_exp_f32 v54, v54
    v_exp_f32 v55, v55
    v_cvt_pk_bf16_f32 v82, v52, v53
    v_exp_f32 v56, v56
    v_exp_f32 v57, v57
    v_cvt_pk_bf16_f32 v83, v54, v55
    v_exp_f32 v58, v58
    v_exp_f32 v59, v59
    v_mfma_f32_32x32x16_bf16 v[96:111], v[28:31], v[80:83], v[96:111]
    s_waitcnt lgkmcnt(0)
    v_cvt_pk_bf16_f32 v84, v56, v57
    v_exp_f32 v60, v60
    v_exp_f32 v61, v61
    v_cvt_pk_bf16_f32 v85, v58, v59
    v_exp_f32 v62, v62
    v_exp_f32 v63, v63
    v_cvt_pk_bf16_f32 v86, v60, v61
    v_exp_f32 v64, v64
    v_exp_f32 v65, v65
    v_cvt_pk_bf16_f32 v87, v62, v63
    v_mfma_f32_32x32x16_bf16 v[48:63], v[20:23], v[10:13], v[112:127]
    ds_read_b128 v[24:27], v6 offset:6144
    v_exp_f32 v66, v66
    v_exp_f32 v67, v67
    v_cvt_pk_bf16_f32 v80, v64, v65
    v_exp_f32 v68, v68
    v_exp_f32 v69, v69
    v_cvt_pk_bf16_f32 v81, v66, v67
    v_mfma_f32_32x32x16_bf16 v[96:111], v[32:35], v[84:87], v[96:111]
    s_mov_b64 exec, s[88:89]
    ds_read_b128 v[28:31], v6 offset:5120
    ds_read_b128 v[32:35], v6 offset:5376
    s_mov_b64 exec, -1
    v_exp_f32 v70, v70
    v_exp_f32 v71, v71
    v_cvt_pk_bf16_f32 v82, v68, v69
    v_exp_f32 v72, v72
    v_exp_f32 v73, v73
    v_cvt_pk_bf16_f32 v83, v70, v71
    v_exp_f32 v74, v74
    v_exp_f32 v75, v75
    v_mfma_f32_32x32x16_bf16 v[96:111], v[36:39], v[80:83], v[96:111]
    s_waitcnt lgkmcnt(0)
    v_cvt_pk_bf16_f32 v84, v72, v73
    v_exp_f32 v76, v76
    v_exp_f32 v77, v77
    v_cvt_pk_bf16_f32 v85, v74, v75
    v_exp_f32 v78, v78
    v_exp_f32 v79, v79
    v_cvt_pk_bf16_f32 v86, v76, v77
    v_exp_f32 v48, v48
    v_exp_f32 v49, v49
    v_cvt_pk_bf16_f32 v87, v78, v79
    v_mfma_f32_32x32x16_bf16 v[64:79], v[24:27], v[10:13], v[112:127]
    ds_read_b128 v[20:23], v6 offset:8192
    v_exp_f32 v50, v50
    v_exp_f32 v51, v51
    v_cvt_pk_bf16_f32 v80, v48, v49
    v_exp_f32 v52, v52
    v_exp_f32 v53, v53
    v_cvt_pk_bf16_f32 v81, v50, v51
    v_mfma_f32_32x32x16_bf16 v[96:111], v[40:43], v[84:87], v[96:111]
    s_mov_b64 exec, s[88:89]
    ds_read_b128 v[36:39], v6 offset:7168
    ds_read_b128 v[40:43], v6 offset:7424
    s_mov_b64 exec, -1
    v_exp_f32 v54, v54
    v_exp_f32 v55, v55
    v_cvt_pk_bf16_f32 v82, v52, v53
    v_exp_f32 v56, v56
    v_exp_f32 v57, v57
    v_cvt_pk_bf16_f32 v83, v54, v55
    v_exp_f32 v58, v58
    v_exp_f32 v59, v59
    v_mfma_f32_32x32x16_bf16 v[96:111], v[28:31], v[80:83], v[96:111]
    s_waitcnt lgkmcnt(0)
    v_cvt_pk_bf16_f32 v84, v56, v57
    v_exp_f32 v60, v60
    v_exp_f32 v61, v61
    v_cvt_pk_bf16_f32 v85, v58, v59
    v_exp_f32 v62, v62
    v_exp_f32 v63, v63
    v_cvt_pk_bf16_f32 v86, v60, v61
    v_exp_f32 v64, v64
    v_exp_f32 v65, v65
    v_cvt_pk_bf16_f32 v87, v62, v63
    v_mfma_f32_32x32x16_bf16 v[48:63], v[20:23], v[10:13], v[112:127]
    ds_read_b128 v[24:27], v6 offset:10240
    v_exp_f32 v66, v66
    v_exp_f32 v67, v67
    v_cvt_pk_bf16_f32 v80, v64, v65
    v_exp_f32 v68, v68
    v_exp_f32 v69, v69
    v_cvt_pk_bf16_f32 v81, v66, v67
    v_mfma_f32_32x32x16_bf16 v[96:111], v[32:35], v[84:87], v[96:111]
    s_mov_b64 exec, s[88:89]
    ds_read_b128 v[28:31], v6 offset:9216
    ds_read_b128 v[32:35], v6 offset:9472
    s_mov_b64 exec, -1
    v_exp_f32 v70, v70
    v_exp_f32 v71, v71
    v_cvt_pk_bf16_f32 v82, v68, v69
    v_exp_f32 v72, v72
    v_exp_f32 v73, v73
    v_cvt_pk_bf16_f32 v83, v70, v71
    v_exp_f32 v74, v74
    v_exp_f32 v75, v75
    v_mfma_f32_32x32x16_bf16 v[96:111], v[36:39], v[80:83], v[96:111]
    s_waitcnt lgkmcnt(0)
    v_cvt_pk_bf16_f32 v84, v72, v73
    v_exp_f32 v76, v76
    v_exp_f32 v77, v77
    v_cvt_pk_bf16_f32 v85, v74, v75
    v_exp_f32 v78, v78
    v_exp_f32 v79, v79
    v_cvt_pk_bf16_f32 v86, v76, v77
    v_add_u32 v6, 0x2000, v6
    s_sub_u32 s19, s19, 1
    s_cbranch_scc0 L_RUN_LOOP_X
    s_setpc_b64 s[10:11]
L_LEAD:
    s_setprio 2
    s_lshl_b32 s78, s68, 9
    s_add_u32 s78, s78, 0x1000
    s_mov_b32 exec_lo, 0xffff
    s_mov_b32 exec_hi, 0x0
    s_mov_b32 s86, 0x8000
    s_waitcnt vmcnt(0)
    s_branch POLLC_37
POLL_35:
    s_sleep 1
    buffer_load_dwordx2 v[184:185], v186, s[36:39], s78 offen sc1
    s_waitcnt vmcnt(0)
POLLC_37:
    v_cmp_ne_u32 vcc, s26, v184
    s_nop 0
    s_cbranch_vccz POLLD_36
    s_sub_u32 s86, s86, 1
    s_cmp_lg_u32 s86, 0
    s_cbranch_scc1 POLL_35
    v_mov_b32 v7, 2
    buffer_store_dword v7, off, s[64:67], 0
POLLD_36:
    s_mov_b64 exec, -1
    s_mov_b32 exec_lo, 0xffff
    s_mov_b32 exec_hi, 0
    v_mov_b32 v6, 155648
    ds_max_u32 v6, v185
    s_mov_b64 exec, -1
    s_lshl_b32 s75, s1, 11
    s_lshl_b32 s77, s1, 14
    s_add_u32 s75, s75, s7
    s_lshl_b32 s76, s70, 11
    s_add_u32 s77, s77, s76
    s_add_u32 s76, s75, 0x10000
    s_mov_b32 m0, s77
    s_nop 0
    buffer_load_dwordx4 v2, s[36:39], s75 offen offset:0 sc1 lds
    buffer_load_dwordx4 v2, s[36:39], s75 offen offset:1024 sc1 lds
    s_add_u32 m0, s77, 8192
    s_nop 0
    buffer_load_dwordx4 v2, s[36:39], s76 offen offset:0 sc1 lds
    buffer_load_dwordx4 v2, s[36:39], s76 offen offset:1024 sc1 lds
    s_add_u32 s1, s1, 1
    s_cmp_eq_u32 s1, 8
    s_cselect_b32 s1, 2, s1
    s_lshl_b32 s75, s1, 11
    s_lshl_b32 s77, s1, 14
    s_add_u32 s75, s75, s7
    s_lshl_b32 s76, s70, 11
    s_add_u32 s77, s77, s76
    s_add_u32 s76, s75, 0x10000
    s_mov_b32 m0, s77
    s_nop 0
    buffer_load_dwordx4 v2, s[36:39], s75 offen offset:0 sc1 lds
    buffer_load_dwordx4 v2, s[36:39], s75 offen offset:1024 sc1 lds
    s_add_u32 m0, s77, 8192
    s_nop 0
    buffer_load_dwordx4 v2, s[36:39], s76 offen offset:0 sc1 lds
    buffer_load_dwordx4 v2, s[36:39], s76 offen offset:1024 sc1 lds
    s_add_u32 s1, s1, 1
    s_cmp_eq_u32 s1, 8
    s_cselect_b32 s1, 2, s1
    s_mov_b32 s19, 0
    s_call_b64 s[10:11], L_ATT_START
    s_lshl_b32 s75, s1, 11
    s_lshl_b32 s77, s1, 14
    s_add_u32 s75, s75, s7
    s_lshl_b32 s76, s70, 11
    s_add_u32 s77, s77, s76
    s_add_u32 s76, s75, 0x10000
    s_mov_b32 m0, s77
    s_nop 0
    buffer_load_dwordx4 v2, s[36:39], s75 offen offset:0 sc1 lds
    buffer_load_dwordx4 v2, s[36:39], s75 offen offset:1024 sc1 lds
    s_add_u32 m0, s77, 8192
    s_nop 0
    buffer_load_dwordx4 v2, s[36:39], s76 offen offset:0 sc1 lds
    buffer_load_dwordx4 v2, s[36:39], s76 offen offset:1024 sc1 lds
    s_add_u32 s1, s1, 1
    s_cmp_eq_u32 s1, 8
    s_cselect_b32 s1, 2, s1
    s_lshl_b32 s75, s1, 11
    s_lshl_b32 s77, s1, 14
    s_add_u32 s75, s75, s7
    s_lshl_b32 s76, s70, 11
    s_add_u32 s77, s77, s76
    s_add_u32 s76, s75, 0x10000
    s_mov_b32 m0, s77
    s_nop 0
    buffer_load_dwordx4 v2, s[36:39], s75 offen offset:0 sc1 lds
    buffer_load_dwordx4 v2, s[36:39], s75 offen offset:1024 sc1 lds
    s_add_u32 m0, s77, 8192
    s_nop 0
    buffer_load_dwordx4 v2, s[36:39], s76 offen offset:0 sc1 lds
    buffer_load_dwordx4 v2, s[36:39], s76 offen offset:1024 sc1 lds
    s_add_u32 s1, s1, 1
    s_cmp_eq_u32 s1, 8
    s_cselect_b32 s1, 2, s1
    s_mov_b32 s19, 0
    s_swappc_b64 s[10:11], s[80:81]
    s_lshl_b32 s75, s1, 11
    s_lshl_b32 s77, s1, 14
    s_add_u32 s75, s75, s7
    s_lshl_b32 s76, s70, 11
    s_add_u32 s77, s77, s76
    s_add_u32 s76, s75, 0x10000
    s_mov_b32 m0, s77
    s_nop 0
    buffer_load_dwordx4 v2, s[36:39], s75 offen offset:0 sc1 lds
    buffer_load_dwordx4 v2, s[36:39], s75 offen offset:1024 sc1 lds
    s_add_u32 m0, s77, 8192
    s_nop 0
    buffer_load_dwordx4 v2, s[36:39], s76 offen offset:0 sc1 lds
    buffer_load_dwordx4 v2, s[36:39], s76 offen offset:1024 sc1 lds
    s_add_u32 s1, s1, 1
    s_cmp_eq_u32 s1, 8
    s_cselect_b32 s1, 2, s1
    s_lshl_b32 s75, s1, 11
    s_lshl_b32 s77, s1, 14
    s_add_u32 s75, s75, s7
    s_lshl_b32 s76, s70, 11
    s_add_u32 s77, s77, s76
    s_add_u32 s76, s75, 0x10000
    s_mov_b32 m0, s77
    s_nop 0
    buffer_load_dwordx4 v2, s[36:39], s75 offen offset:0 sc1 lds
    buffer_load_dwordx4 v2, s[36:39], s75 offen offset:1024 sc1 lds
    s_add_u32 m0, s77, 8192
    s_nop 0
    buffer_load_dwordx4 v2, s[36:39], s76 offen offset:0 sc1 lds
    buffer_load_dwordx4 v2, s[36:39], s76 offen offset:1024 sc1 lds
    s_add_u32 s1, s1, 1
    s_cmp_eq_u32 s1, 8
    s_cselect_b32 s1, 2, s1
    s_lshl_b32 s76, s69, 11
    s_add_u32 s76, s76, 0x14000
    buffer_load_dwordx4 v[160:163], v2, s[36:39], s76 offen offset:0 sc1
    buffer_load_dwordx4 v[164:167], v2, s[36:39], s76 offen offset:1024 sc1
    s_lshr_b32 s95, s2, 3
    s_cmp_ge_u32 s70, 2
    s_cbranch_scc1 L_TC_38
    v_lshrrev_b32 v236, 2, v1
    s_movk_i32 s94, 3584
    v_and_b32 v235, 3, v1
    v_lshlrev_b32 v235, 7, v235
    v_mad_u32_u24 v236, v236, s94, v235
    s_lshl_b32 s95, s95, 1
    s_and_b32 s94, s70, 1
    s_add_u32 s95, s95, s94
    s_mul_i32 s95, s95, 28672
    s_mul_i32 s94, s71, 448
    s_and_b32 s94, s94, 0xffffff80
    s_add_u32 s95, s95, s94
    s_mov_b32 exec_hi, 0
    buffer_load_dword v235, v236, s[48:51], s95 offen
    buffer_load_dword v236, v236, s[52:55], s95 offen
    s_branch L_TC_40
L_TC_38:
    v_lshlrev_b32 v236, 7, v1
    s_and_b32 s94, s70, 1
    s_lshl_b32 s73, s95, 1
    s_add_u32 s73, s73, s94
    s_lshl_b32 s73, s73, 13
    buffer_load_dword v235, v236, s[40:43], s73 offen
    s_mul_i32 s95, s95, 7168
    s_mul_i32 s73, s71, 229376
    s_add_u32 s95, s95, s73
    s_mul_i32 s94, s94, 3584
    s_add_u32 s95, s95, s94
    s_mov_b32 exec_lo, 0xfffffff
    s_mov_b32 exec_hi, 0x0
    buffer_load_dword v236, v236, s[56:59], s95 offen
L_TC_40:
    s_mov_b64 exec, -1
    s_mov_b32 s19, 0
    s_swappc_b64 s[10:11], s[80:81]
    s_waitcnt vmcnt(4)
    v_mov_b32 v184, 155656
    v_mov_b32 v185, 1
    s_mov_b64 exec, 1
    ds_add_u32 v184, v185
    s_mov_b64 exec, -1
    v_mov_b32 v188, 155648
    s_mov_b32 s86, 0x100000
    s_mov_b32 s76, 0x44f20000
L_AW_43:
    ds_read_b128 v[184:187], v188
    s_waitcnt lgkmcnt(0)
    v_cmp_le_u32 vcc, 12, v186
    v_mul_f32 v184, v184, v185
    s_cbranch_vccnz L_AD_44
    s_sleep 1
    s_sub_u32 s86, s86, 1
    s_cmp_lg_u32 s86, 0
    s_cbranch_scc1 L_AW_43
    v_mov_b32 v185, 14
    buffer_store_dword v185, off, s[64:67], 0
L_AD_44:
    v_cmp_nge_f32 vcc, s76, v184
    s_nop 0
    s_cbranch_vccz L_OK_42
    s_call_b64 s[84:85], L_FALLBACK
L_OK_42:
    s_mov_b32 s19, 0
    s_swappc_b64 s[10:11], s[80:81]
    s_mov_b32 s86, 0x8000
    s_waitcnt vmcnt(2)
    s_branch POLLC_48
POLL_46:
    s_lshl_b32 s76, s69, 11
    s_add_u32 s76, s76, 0x14000
    buffer_load_dwordx4 v[160:163], v2, s[36:39], s76 offen offset:0 sc1
    buffer_load_dwordx4 v[164:167], v2, s[36:39], s76 offen offset:1024 sc1
    s_waitcnt vmcnt(0)
POLLC_48:
    v_or_b32 v192, v160, v162
    v_and_b32 v193, v160, v162
    v_or3_b32 v192, v192, v164, v166
    v_bitop3_b32 v193, v193, v164, v166 bitop3:0x80
    v_xor_b32 v192, s26, v192
    v_xor_b32 v193, s26, v193
    v_or_b32 v192, v192, v193
    v_cmp_ne_u32 vcc, 0, v192
    s_nop 0
    s_cbranch_vccz POLLD_47
    s_sub_u32 s86, s86, 1
    s_cmp_lg_u32 s86, 0
    s_cbranch_scc1 POLL_46
    v_mov_b32 v192, 9
    buffer_store_dword v192, off, s[64:67], 0
POLLD_47:
    v_cmp_lt_u32 s[16:17], s3, v161
    v_cmp_lt_u32 s[18:19], s61, v161
    v_cmp_lt_u32 s[20:21], s3, v163
    v_cmp_lt_u32 s[22:23], s61, v163
    v_cmp_lt_u32 s[92:93], s3, v165
    v_cmp_lt_u32 s[94:95], s61, v165
    v_cmp_lt_u32 s[96:97], s3, v167
    v_cmp_lt_u32 s[4:5], s61, v167
    s_bcnt1_i32_b64 s16, s[16:17]
    s_bcnt1_i32_b64 s18, s[18:19]
    s_bcnt1_i32_b64 s20, s[20:21]
    s_bcnt1_i32_b64 s22, s[22:23]
    s_bcnt1_i32_b64 s92, s[92:93]
    s_bcnt1_i32_b64 s94, s[94:95]
    s_bcnt1_i32_b64 s96, s[96:97]
    s_bcnt1_i32_b64 s4, s[4:5]
    s_add_u32 s78, s16, s20
    s_add_u32 s77, s18, s22
    s_add_u32 s79, s92, s96
    s_add_u32 s76, s94, s4
    s_add_u32 s78, s78, s79
    s_add_u32 s77, s77, s76
    s_min_u32 s79, s78, s77
    s_cmp_ge_u32 s79, 8
    s_cbranch_scc1 L_RK_45
    s_mov_b32 s76, 0x14000
    buffer_load_dwordx4 v[128:131], v2, s[36:39], s76 offen offset:0 sc1
    buffer_load_dwordx4 v[132:135], v2, s[36:39], s76 offen offset:1024 sc1
    buffer_load_dwordx4 v[136:139], v2, s[36:39], s76 offen offset:2048 sc1
    buffer_load_dwordx4 v[140:143], v2, s[36:39], s76 offen offset:3072 sc1
    s_add_u32 s76, s76, 4096
    buffer_load_dwordx4 v[144:147], v2, s[36:39], s76 offen offset:0 sc1
    buffer_load_dwordx4 v[148:151], v2, s[36:39], s76 offen offset:1024 sc1
    buffer_load_dwordx4 v[152:155], v2, s[36:39], s76 offen offset:2048 sc1
    buffer_load_dwordx4 v[156:159], v2, s[36:39], s76 offen offset:3072 sc1
    s_add_u32 s76, s76, 4096
    buffer_load_dwordx4 v[160:163], v2, s[36:39], s76 offen offset:0 sc1
    buffer_load_dwordx4 v[164:167], v2, s[36:39], s76 offen offset:1024 sc1
    buffer_load_dwordx4 v[168:171], v2, s[36:39], s76 offen offset:2048 sc1
    buffer_load_dwordx4 v[172:175], v2, s[36:39], s76 offen offset:3072 sc1
    s_add_u32 s76, s76, 4096
    buffer_load_dwordx4 v[176:179], v2, s[36:39], s76 offen offset:0 sc1
    buffer_load_dwordx4 v[180:183], v2, s[36:39], s76 offen offset:1024 sc1
    buffer_load_dwordx4 v[184:187], v2, s[36:39], s76 offen offset:2048 sc1
    buffer_load_dwordx4 v[188:191], v2, s[36:39], s76 offen offset:3072 sc1
L_RK_45:
    v_mov_b32 v198, 155660
    v_mov_b32 v199, 1
    s_mov_b64 exec, 1
    ds_add_u32 v198, v199
    s_mov_b64 exec, -1
    s_cmp_lg_u32 s87, 0
    s_cbranch_scc1 L_LEADF
    s_add_u32 s95, s24, s25
    s_add_u32 m0, s12, 0
    s_add_u32 s94, s95, 15360
    buffer_load_dwordx4 v8, s[40:43], s95 offen lds
    buffer_load_dwordx4 v8, s[40:43], s94 offen offset:1024 lds
    s_add_u32 s25, s25, 32768
    s_and_b32 s25, s25, 0x3ffff
    s_add_u32 s95, s24, s25
    s_add_u32 m0, s12, 2048
    s_add_u32 s94, s95, 15360
    buffer_load_dwordx4 v8, s[40:43], s95 offen lds
    buffer_load_dwordx4 v8, s[40:43], s94 offen offset:1024 lds
    s_add_u32 s25, s25, 32768
    s_and_b32 s25, s25, 0x3ffff
    s_add_u32 s95, s24, s25
    s_add_u32 m0, s12, 4096
    s_add_u32 s94, s95, 15360
    buffer_load_dwordx4 v8, s[40:43], s95 offen lds
    buffer_load_dwordx4 v8, s[40:43], s94 offen offset:1024 lds
    s_add_u32 s25, s25, 32768
    s_and_b32 s25, s25, 0x3ffff
    s_mov_b32 s19, 0
    s_swappc_b64 s[10:11], s[80:81]
    s_waitcnt vmcnt(0)
    s_min_u32 s79, s78, s77
    s_cmp_ge_u32 s79, 8
    s_cbranch_scc1 L_RK_49
    s_mov_b32 s86, 0x8000
    s_waitcnt vmcnt(0)
    s_branch POLLC_52
POLL_50:
    s_mov_b32 s76, 0x14000
    buffer_load_dwordx4 v[128:131], v2, s[36:39], s76 offen offset:0 sc1
    buffer_load_dwordx4 v[132:135], v2, s[36:39], s76 offen offset:1024 sc1
    buffer_load_dwordx4 v[136:139], v2, s[36:39], s76 offen offset:2048 sc1
    buffer_load_dwordx4 v[140:143], v2, s[36:39], s76 offen offset:3072 sc1
    s_add_u32 s76, s76, 4096
    buffer_load_dwordx4 v[144:147], v2, s[36:39], s76 offen offset:0 sc1
    buffer_load_dwordx4 v[148:151], v2, s[36:39], s76 offen offset:1024 sc1
    buffer_load_dwordx4 v[152:155], v2, s[36:39], s76 offen offset:2048 sc1
    buffer_load_dwordx4 v[156:159], v2, s[36:39], s76 offen offset:3072 sc1
    s_add_u32 s76, s76, 4096
    buffer_load_dwordx4 v[160:163], v2, s[36:39], s76 offen offset:0 sc1
    buffer_load_dwordx4 v[164:167], v2, s[36:39], s76 offen offset:1024 sc1
    buffer_load_dwordx4 v[168:171], v2, s[36:39], s76 offen offset:2048 sc1
    buffer_load_dwordx4 v[172:175], v2, s[36:39], s76 offen offset:3072 sc1
    s_add_u32 s76, s76, 4096
    buffer_load_dwordx4 v[176:179], v2, s[36:39], s76 offen offset:0 sc1
    buffer_load_dwordx4 v[180:183], v2, s[36:39], s76 offen offset:1024 sc1
    buffer_load_dwordx4 v[184:187], v2, s[36:39], s76 offen offset:2048 sc1
    buffer_load_dwordx4 v[188:191], v2, s[36:39], s76 offen offset:3072 sc1
    s_waitcnt vmcnt(0)
POLLC_52:
    v_or_b32 v192, v128, v130
    v_and_b32 v193, v128, v130
    v_or3_b32 v192, v192, v132, v134
    v_bitop3_b32 v193, v193, v132, v134 bitop3:0x80
    v_or3_b32 v192, v192, v136, v138
    v_bitop3_b32 v193, v193, v136, v138 bitop3:0x80
    v_or3_b32 v192, v192, v140, v142
    v_bitop3_b32 v193, v193, v140, v142 bitop3:0x80
    v_or3_b32 v192, v192, v144, v146
    v_bitop3_b32 v193, v193, v144, v146 bitop3:0x80
    v_or3_b32 v192, v192, v148, v150
    v_bitop3_b32 v193, v193, v148, v150 bitop3:0x80
    v_or3_b32 v192, v192, v152, v154
    v_bitop3_b32 v193, v193, v152, v154 bitop3:0x80
    v_or3_b32 v192, v192, v156, v158
    v_bitop3_b32 v193, v193, v156, v158 bitop3:0x80
    v_or3_b32 v192, v192, v160, v162
    v_bitop3_b32 v193, v193, v160, v162 bitop3:0x80
    v_or3_b32 v192, v192, v164, v166
    v_bitop3_b32 v193, v193, v164, v166 bitop3:0x80
    v_or3_b32 v192, v192, v168, v170
    v_bitop3_b32 v193, v193, v168, v170 bitop3:0x80
    v_or3_b32 v192, v192, v172, v174
    v_bitop3_b32 v193, v193, v172, v174 bitop3:0x80
    v_or3_b32 v192, v192, v176, v178
    v_bitop3_b32 v193, v193, v176, v178 bitop3:0x80
    v_or3_b32 v192, v192, v180, v182
    v_bitop3_b32 v193, v193, v180, v182 bitop3:0x80
    v_or3_b32 v192, v192, v184, v186
    v_bitop3_b32 v193, v193, v184, v186 bitop3:0x80
    v_or3_b32 v192, v192, v188, v190
    v_bitop3_b32 v193, v193, v188, v190 bitop3:0x80
    v_xor_b32 v192, s26, v192
    v_xor_b32 v193, s26, v193
    v_or_b32 v192, v192, v193
    v_cmp_ne_u32 vcc, 0, v192
    s_nop 0
    s_cbranch_vccz POLLD_51
    s_sub_u32 s86, s86, 1
    s_cmp_lg_u32 s86, 0
    s_cbranch_scc1 POLL_50
    v_mov_b32 v192, 13
    buffer_store_dword v192, off, s[64:67], 0
POLLD_51:
    s_cmp_ge_u32 s78, 8
    s_cbranch_scc1 L_NS_53
    v_mov_b32 v194, 0
    v_mov_b32 v195, 0
    v_cmp_lt_u32 s[16:17], s3, v129
    v_cmp_lt_u32 s[18:19], s3, v131
    v_cmp_lt_u32 s[20:21], s3, v133
    v_cmp_lt_u32 s[22:23], s3, v135
    v_addc_co_u32 v194, s[16:17], 0, v194, s[16:17]
    v_addc_co_u32 v195, s[18:19], 0, v195, s[18:19]
    v_addc_co_u32 v194, s[20:21], 0, v194, s[20:21]
    v_addc_co_u32 v195, s[22:23], 0, v195, s[22:23]
    v_cmp_lt_u32 s[16:17], s3, v137
    v_cmp_lt_u32 s[18:19], s3, v139
    v_cmp_lt_u32 s[20:21], s3, v141
    v_cmp_lt_u32 s[22:23], s3, v143
    v_addc_co_u32 v194, s[16:17], 0, v194, s[16:17]
    v_addc_co_u32 v195, s[18:19], 0, v195, s[18:19]
    v_addc_co_u32 v194, s[20:21], 0, v194, s[20:21]
    v_addc_co_u32 v195, s[22:23], 0, v195, s[22:23]
    v_cmp_lt_u32 s[16:17], s3, v145
    v_cmp_lt_u32 s[18:19], s3, v147
    v_cmp_lt_u32 s[20:21], s3, v149
    v_cmp_lt_u32 s[22:23], s3, v151
    v_addc_co_u32 v194, s[16:17], 0, v194, s[16:17]
    v_addc_co_u32 v195, s[18:19], 0, v195, s[18:19]
    v_addc_co_u32 v194, s[20:21], 0, v194, s[20:21]
    v_addc_co_u32 v195, s[22:23], 0, v195, s[22:23]
    v_cmp_lt_u32 s[16:17], s3, v153
    v_cmp_lt_u32 s[18:19], s3, v155
    v_cmp_lt_u32 s[20:21], s3, v157
    v_cmp_lt_u32 s[22:23], s3, v159
    v_addc_co_u32 v194, s[16:17], 0, v194, s[16:17]
    v_addc_co_u32 v195, s[18:19], 0, v195, s[18:19]
    v_addc_co_u32 v194, s[20:21], 0, v194, s[20:21]
    v_addc_co_u32 v195, s[22:23], 0, v195, s[22:23]
    v_cmp_lt_u32 s[16:17], s3, v161
    v_cmp_lt_u32 s[18:19], s3, v163
    v_cmp_lt_u32 s[20:21], s3, v165
    v_cmp_lt_u32 s[22:23], s3, v167
    v_addc_co_u32 v194, s[16:17], 0, v194, s[16:17]
    v_addc_co_u32 v195, s[18:19], 0, v195, s[18:19]
    v_addc_co_u32 v194, s[20:21], 0, v194, s[20:21]
    v_addc_co_u32 v195, s[22:23], 0, v195, s[22:23]
    v_cmp_lt_u32 s[16:17], s3, v169
    v_cmp_lt_u32 s[18:19], s3, v171
    v_cmp_lt_u32 s[20:21], s3, v173
    v_cmp_lt_u32 s[22:23], s3, v175
    v_addc_co_u32 v194, s[16:17], 0, v194, s[16:17]
    v_addc_co_u32 v195, s[18:19], 0, v195, s[18:19]
    v_addc_co_u32 v194, s[20:21], 0, v194, s[20:21]
    v_addc_co_u32 v195, s[22:23], 0, v195, s[22:23]
    v_cmp_lt_u32 s[16:17], s3, v177
    v_cmp_lt_u32 s[18:19], s3, v179
    v_cmp_lt_u32 s[20:21], s3, v181
    v_cmp_lt_u32 s[22:23], s3, v183
    v_addc_co_u32 v194, s[16:17], 0, v194, s[16:17]
    v_addc_co_u32 v195, s[18:19], 0, v195, s[18:19]
    v_addc_co_u32 v194, s[20:21], 0, v194, s[20:21]
    v_addc_co_u32 v195, s[22:23], 0, v195, s[22:23]
    v_cmp_lt_u32 s[16:17], s3, v185
    v_cmp_lt_u32 s[18:19], s3, v187
    v_cmp_lt_u32 s[20:21], s3, v189
    v_cmp_lt_u32 s[22:23], s3, v191
    v_addc_co_u32 v194, s[16:17], 0, v194, s[16:17]
    v_addc_co_u32 v195, s[18:19], 0, v195, s[18:19]
    v_addc_co_u32 v194, s[20:21], 0, v194, s[20:21]
    v_addc_co_u32 v195, s[22:23], 0, v195, s[22:23]
    v_add_u32 v194, v194, v195
    s_nop 1
    v_add_u32_dpp v194, v194, v194 row_shr:1 row_mask:0xf bank_mask:0xf bound_ctrl:0
    s_nop 1
    v_add_u32_dpp v194, v194, v194 row_shr:2 row_mask:0xf bank_mask:0xf bound_ctrl:0
    s_nop 1
    v_add_u32_dpp v194, v194, v194 row_shr:4 row_mask:0xf bank_mask:0xf bound_ctrl:0
    s_nop 1
    v_add_u32_dpp v194, v194, v194 row_shr:8 row_mask:0xf bank_mask:0xf bound_ctrl:0
    s_nop 1
    v_add_u32_dpp v194, v194, v194 row_bcast:15 row_mask:0xa bank_mask:0xf
    s_nop 1
    v_add_u32_dpp v194, v194, v194 row_bcast:31 row_mask:0xc bank_mask:0xf
    s_nop 0
    v_readlane_b32 s78, v194, 63
    s_nop 0
    s_cmp_ge_u32 s78, 8
    s_cbranch_scc1 L_NS_53
    s_lshl_b32 s76, s78, 10
    s_add_u32 s76, s76, 0x8000
    buffer_store_dwordx4 v[244:247], v2, s[36:39], s76 offen sc1
    v_mov_b32 v197, s3
    v_ashrrev_i32 v196, 31, v197
    v_not_b32 v196, v196
    v_or_b32 v196, 0x80000000, v196
    v_xor_b32 v196, v196, v197
    v_and_b32 v196, 0xffff0000, v196
    v_mul_f32 v196, 0xbfb8aa3b, v196
    v_exp_f32 v196, v196
    s_nop 0
    v_add_f32 v196, 1.0, v196
    v_rcp_f32 v196, v196
    s_nop 0
    v_cvt_pk_bf16_f32 v196, v196, v196
    v_and_b32 v196, 0xffff0000, v196
    s_add_u32 s76, s99, 0
    v_or_b32 v14, s76, v196
    s_lshl_b32 s14, s78, 7
    s_add_u32 s14, s14, 0x7000
L_NS_53:
    s_cmp_ge_u32 s77, 8
    s_cbranch_scc1 L_NS_54
    v_mov_b32 v194, 0
    v_mov_b32 v195, 0
    v_cmp_lt_u32 s[16:17], s61, v129
    v_cmp_lt_u32 s[18:19], s61, v131
    v_cmp_lt_u32 s[20:21], s61, v133
    v_cmp_lt_u32 s[22:23], s61, v135
    v_addc_co_u32 v194, s[16:17], 0, v194, s[16:17]
    v_addc_co_u32 v195, s[18:19], 0, v195, s[18:19]
    v_addc_co_u32 v194, s[20:21], 0, v194, s[20:21]
    v_addc_co_u32 v195, s[22:23], 0, v195, s[22:23]
    v_cmp_lt_u32 s[16:17], s61, v137
    v_cmp_lt_u32 s[18:19], s61, v139
    v_cmp_lt_u32 s[20:21], s61, v141
    v_cmp_lt_u32 s[22:23], s61, v143
    v_addc_co_u32 v194, s[16:17], 0, v194, s[16:17]
    v_addc_co_u32 v195, s[18:19], 0, v195, s[18:19]
    v_addc_co_u32 v194, s[20:21], 0, v194, s[20:21]
    v_addc_co_u32 v195, s[22:23], 0, v195, s[22:23]
    v_cmp_lt_u32 s[16:17], s61, v145
    v_cmp_lt_u32 s[18:19], s61, v147
    v_cmp_lt_u32 s[20:21], s61, v149
    v_cmp_lt_u32 s[22:23], s61, v151
    v_addc_co_u32 v194, s[16:17], 0, v194, s[16:17]
    v_addc_co_u32 v195, s[18:19], 0, v195, s[18:19]
    v_addc_co_u32 v194, s[20:21], 0, v194, s[20:21]
    v_addc_co_u32 v195, s[22:23], 0, v195, s[22:23]
    v_cmp_lt_u32 s[16:17], s61, v153
    v_cmp_lt_u32 s[18:19], s61, v155
    v_cmp_lt_u32 s[20:21], s61, v157
    v_cmp_lt_u32 s[22:23], s61, v159
    v_addc_co_u32 v194, s[16:17], 0, v194, s[16:17]
    v_addc_co_u32 v195, s[18:19], 0, v195, s[18:19]
    v_addc_co_u32 v194, s[20:21], 0, v194, s[20:21]
    v_addc_co_u32 v195, s[22:23], 0, v195, s[22:23]
    v_cmp_lt_u32 s[16:17], s61, v161
    v_cmp_lt_u32 s[18:19], s61, v163
    v_cmp_lt_u32 s[20:21], s61, v165
    v_cmp_lt_u32 s[22:23], s61, v167
    v_addc_co_u32 v194, s[16:17], 0, v194, s[16:17]
    v_addc_co_u32 v195, s[18:19], 0, v195, s[18:19]
    v_addc_co_u32 v194, s[20:21], 0, v194, s[20:21]
    v_addc_co_u32 v195, s[22:23], 0, v195, s[22:23]
    v_cmp_lt_u32 s[16:17], s61, v169
    v_cmp_lt_u32 s[18:19], s61, v171
    v_cmp_lt_u32 s[20:21], s61, v173
    v_cmp_lt_u32 s[22:23], s61, v175
    v_addc_co_u32 v194, s[16:17], 0, v194, s[16:17]
    v_addc_co_u32 v195, s[18:19], 0, v195, s[18:19]
    v_addc_co_u32 v194, s[20:21], 0, v194, s[20:21]
    v_addc_co_u32 v195, s[22:23], 0, v195, s[22:23]
    v_cmp_lt_u32 s[16:17], s61, v177
    v_cmp_lt_u32 s[18:19], s61, v179
    v_cmp_lt_u32 s[20:21], s61, v181
    v_cmp_lt_u32 s[22:23], s61, v183
    v_addc_co_u32 v194, s[16:17], 0, v194, s[16:17]
    v_addc_co_u32 v195, s[18:19], 0, v195, s[18:19]
    v_addc_co_u32 v194, s[20:21], 0, v194, s[20:21]
    v_addc_co_u32 v195, s[22:23], 0, v195, s[22:23]
    v_cmp_lt_u32 s[16:17], s61, v185
    v_cmp_lt_u32 s[18:19], s61, v187
    v_cmp_lt_u32 s[20:21], s61, v189
    v_cmp_lt_u32 s[22:23], s61, v191
    v_addc_co_u32 v194, s[16:17], 0, v194, s[16:17]
    v_addc_co_u32 v195, s[18:19], 0, v195, s[18:19]
    v_addc_co_u32 v194, s[20:21], 0, v194, s[20:21]
    v_addc_co_u32 v195, s[22:23], 0, v195, s[22:23]
    v_add_u32 v194, v194, v195
    s_nop 1
    v_add_u32_dpp v194, v194, v194 row_shr:1 row_mask:0xf bank_mask:0xf bound_ctrl:0
    s_nop 1
    v_add_u32_dpp v194, v194, v194 row_shr:2 row_mask:0xf bank_mask:0xf bound_ctrl:0
    s_nop 1
    v_add_u32_dpp v194, v194, v194 row_shr:4 row_mask:0xf bank_mask:0xf bound_ctrl:0
    s_nop 1
    v_add_u32_dpp v194, v194, v194 row_shr:8 row_mask:0xf bank_mask:0xf bound_ctrl:0
    s_nop 1
    v_add_u32_dpp v194, v194, v194 row_bcast:15 row_mask:0xa bank_mask:0xf
    s_nop 1
    v_add_u32_dpp v194, v194, v194 row_bcast:31 row_mask:0xc bank_mask:0xf
    s_nop 0
    v_readlane_b32 s77, v194, 63
    s_nop 0
    s_cmp_ge_u32 s77, 8
    s_cbranch_scc1 L_NS_54
    s_lshl_b32 s76, s77, 10
    s_add_u32 s76, s76, 0x8000
    buffer_store_dwordx4 v[240:243], v2, s[36:39], s76 offen sc1
    v_mov_b32 v197, s61
    v_ashrrev_i32 v196, 31, v197
    v_not_b32 v196, v196
    v_or_b32 v196, 0x80000000, v196
    v_xor_b32 v196, v196, v197
    v_and_b32 v196, 0xffff0000, v196
    v_mul_f32 v196, 0xbfb8aa3b, v196
    v_exp_f32 v196, v196
    s_nop 0
    v_add_f32 v196, 1.0, v196
    v_rcp_f32 v196, v196
    s_nop 0
    v_cvt_pk_bf16_f32 v196, v196, v196
    v_and_b32 v196, 0xffff0000, v196
    s_add_u32 s76, s99, 1
    v_or_b32 v15, s76, v196
    s_lshl_b32 s15, s77, 7
    s_add_u32 s15, s15, 0x7000
L_NS_54:
L_RK_49:
    ds_read_b64_tr_b16 v[128:129], v9 offset:0
    ds_read_b64_tr_b16 v[130:131], v9 offset:512
    ds_read_b64_tr_b16 v[132:133], v9 offset:1024
    ds_read_b64_tr_b16 v[134:135], v9 offset:1536
    ds_read_b64_tr_b16 v[136:137], v9 offset:2048
    ds_read_b64_tr_b16 v[138:139], v9 offset:2560
    ds_read_b64_tr_b16 v[140:141], v9 offset:3072
    ds_read_b64_tr_b16 v[142:143], v9 offset:3584
    ds_read_b64_tr_b16 v[144:145], v9 offset:4096
    ds_read_b64_tr_b16 v[146:147], v9 offset:4608
    ds_read_b64_tr_b16 v[148:149], v9 offset:5120
    ds_read_b64_tr_b16 v[150:151], v9 offset:5632
    s_mov_b32 s19, 0
    s_swappc_b64 s[10:11], s[80:81]
    s_cmp_eq_u32 s14, 0
    s_cbranch_scc1 L_SP_55
    v_mov_b32 v184, s26
    v_mov_b32 v185, v14
    v_lshlrev_b32 v186, 3, v1
    s_mov_b32 exec_lo, 0xffff
    s_mov_b32 exec_hi, 0
    s_waitcnt vmcnt(0)
    buffer_store_dwordx2 v[184:185], v186, s[36:39], s14 offen sc1
    s_mov_b64 exec, -1
L_SP_55:
    s_cmp_eq_u32 s15, 0
    s_cbranch_scc1 L_SP_56
    v_mov_b32 v184, s26
    v_mov_b32 v185, v15
    v_lshlrev_b32 v186, 3, v1
    s_mov_b32 exec_lo, 0xffff
    s_mov_b32 exec_hi, 0
    s_waitcnt vmcnt(0)
    buffer_store_dwordx2 v[184:185], v186, s[36:39], s15 offen sc1
    s_mov_b64 exec, -1
L_SP_56:
    s_add_u32 s95, s24, s25
    s_add_u32 m0, s12, 0
    s_add_u32 s94, s95, 15360
    buffer_load_dwordx4 v8, s[40:43], s95 offen lds
    buffer_load_dwordx4 v8, s[40:43], s94 offen offset:1024 lds
    s_add_u32 s25, s25, 32768
    s_and_b32 s25, s25, 0x3ffff
    s_add_u32 s95, s24, s25
    s_add_u32 m0, s12, 2048
    s_add_u32 s94, s95, 15360
    buffer_load_dwordx4 v8, s[40:43], s95 offen lds
    buffer_load_dwordx4 v8, s[40:43], s94 offen offset:1024 lds
    s_add_u32 s25, s25, 32768
    s_and_b32 s25, s25, 0x3ffff
    s_add_u32 s95, s24, s25
    s_add_u32 m0, s12, 4096
    s_add_u32 s94, s95, 15360
    buffer_load_dwordx4 v8, s[40:43], s95 offen lds
    buffer_load_dwordx4 v8, s[40:43], s94 offen offset:1024 lds
    s_add_u32 s25, s25, 32768
    s_and_b32 s25, s25, 0x3ffff
    s_mov_b32 s19, 1
    s_swappc_b64 s[10:11], s[80:81]
    s_waitcnt vmcnt(0)
    ds_read_b64_tr_b16 v[152:153], v9 offset:0
    ds_read_b64_tr_b16 v[154:155], v9 offset:512
    ds_read_b64_tr_b16 v[156:157], v9 offset:1024
    ds_read_b64_tr_b16 v[158:159], v9 offset:1536
    ds_read_b64_tr_b16 v[160:161], v9 offset:2048
    ds_read_b64_tr_b16 v[162:163], v9 offset:2560
    ds_read_b64_tr_b16 v[164:165], v9 offset:3072
    ds_read_b64_tr_b16 v[166:167], v9 offset:3584
    ds_read_b64_tr_b16 v[168:169], v9 offset:4096
    ds_read_b64_tr_b16 v[170:171], v9 offset:4608
    ds_read_b64_tr_b16 v[172:173], v9 offset:5120
    ds_read_b64_tr_b16 v[174:175], v9 offset:5632
    s_mov_b32 s19, 0
    s_swappc_b64 s[10:11], s[80:81]
    s_add_u32 s95, s24, s25
    s_add_u32 m0, s12, 0
    s_add_u32 s94, s95, 15360
    buffer_load_dwordx4 v8, s[40:43], s95 offen lds
    buffer_load_dwordx4 v8, s[40:43], s94 offen offset:1024 lds
    s_add_u32 s25, s25, 32768
    s_and_b32 s25, s25, 0x3ffff
    s_add_u32 s95, s24, s25
    s_add_u32 m0, s12, 2048
    s_add_u32 s94, s95, 15360
    buffer_load_dwordx4 v8, s[40:43], s95 offen lds
    buffer_load_dwordx4 v8, s[40:43], s94 offen offset:1024 lds
    s_add_u32 s25, s25, 32768
    s_and_b32 s25, s25, 0x3ffff
    s_mov_b32 s19, 1
    s_swappc_b64 s[10:11], s[80:81]
    s_waitcnt vmcnt(0)
    ds_read_b64_tr_b16 v[176:177], v9 offset:0
    ds_read_b64_tr_b16 v[178:179], v9 offset:512
    ds_read_b64_tr_b16 v[180:181], v9 offset:1024
    ds_read_b64_tr_b16 v[182:183], v9 offset:1536
    ds_read_b64_tr_b16 v[184:185], v9 offset:2048
    ds_read_b64_tr_b16 v[186:187], v9 offset:2560
    ds_read_b64_tr_b16 v[188:189], v9 offset:3072
    ds_read_b64_tr_b16 v[190:191], v9 offset:3584
    s_mov_b32 s95, 0x7000
    s_mov_b32 exec_lo, 0xff
    s_mov_b32 exec_hi, 0x0
    buffer_load_dwordx2 v[14:15], v17, s[36:39], s95 offen sc1
    s_mov_b64 exec, -1
    s_mov_b32 s19, 0
    s_swappc_b64 s[10:11], s[80:81]
    s_setprio 0
    s_mov_b32 s19, 2
    s_swappc_b64 s[10:11], s[80:81]
    s_setprio 3
    s_mov_b32 s95, 0x7000
    s_mov_b32 exec_lo, 0xff
    s_mov_b32 exec_hi, 0x0
    s_mov_b32 s86, 0x8000
    s_waitcnt vmcnt(0)
    s_branch POLLC_60
POLL_58:
    s_sleep 1
    buffer_load_dwordx2 v[14:15], v17, s[36:39], s95 offen sc1
    s_waitcnt vmcnt(0)
POLLC_60:
    v_cmp_ne_u32 vcc, s26, v14
    s_nop 0
    s_cbranch_vccz POLLD_59
    s_sub_u32 s86, s86, 1
    s_cmp_lg_u32 s86, 0
    s_cbranch_scc1 POLL_58
    v_mov_b32 v7, 3
    buffer_store_dword v7, off, s[64:67], 0
POLLD_59:
    s_mov_b64 exec, -1
    s_lshl_b32 s95, s69, 3
    s_add_u32 s95, s95, s71
    v_bfe_u32 v7, v15, 5, 6
    s_mov_b64 exec, 0xff
    v_cmp_eq_u32 vcc, s95, v7
    s_mov_b64 exec, -1
    s_mov_b32 s98, vcc_lo
    s_cmp_eq_u32 s98, 0
    s_cbranch_scc1 L_SR_57
    v_lshrrev_b32 v16, 5, v0
    v_lshlrev_b32 v16, 14, v16
    v_and_b32 v7, 31, v0
    v_lshl_add_u32 v16, v7, 4, v16
    s_ff1_i32_b32 s96, s98
    s_lshl_b32 s73, s96, 11
    s_lshl_b32 s74, s72, 9
    s_add_u32 s73, s73, s74
    s_add_u32 s73, s73, 0x20000
    buffer_load_dwordx4 v[224:227], v16, s[36:39], s73 offen sc1
    s_add_u32 s73, s73, 0x40000
    buffer_load_dwordx4 v[228:231], v16, s[36:39], s73 offen sc1
    s_add_u32 s73, s73, 0x40000
    buffer_load_dwordx4 v[232:235], v16, s[36:39], s73 offen sc1
    s_add_u32 s73, s73, 0x40000
    s_cmp_ge_u32 s70, 4
    s_cselect_b32 s74, 0, 1.0
    s_cbranch_scc0 L_Y3_61
    s_sub_u32 s73, s73, 0x40000
L_Y3_61:
    buffer_load_dwordx4 v[236:239], v16, s[36:39], s73 offen sc1
L_SR_57:
    s_setprio 0
    s_mov_b32 s19, 0
    s_swappc_b64 s[10:11], s[80:81]
    s_cmp_eq_u32 s91, 0
    s_cbranch_scc1 L_RUN_EXIT
    s_branch L_ATT_DONE
L_LEADF:
    s_add_u32 m0, s12, 0
    s_mul_i32 s94, s70, 229376
    s_lshl_b32 s95, s9, 6
    s_add_u32 s94, s94, s95
    s_add_u32 s94, s94, 0
    s_add_u32 s95, s94, 56320
    buffer_load_dwordx4 v237, s[48:51], s94 offen lds
    buffer_load_dwordx4 v237, s[48:51], s95 offen offset:1024 lds
    s_add_u32 m0, s12, 2048
    s_mul_i32 s94, s70, 229376
    s_lshl_b32 s95, s9, 6
    s_add_u32 s94, s94, s95
    s_add_u32 s94, s94, 114688
    s_add_u32 s95, s94, 56320
    buffer_load_dwordx4 v237, s[48:51], s94 offen lds
    buffer_load_dwordx4 v237, s[48:51], s95 offen offset:1024 lds
    s_add_u32 m0, s12, 4096
    s_mul_i32 s94, s70, 229376
    s_lshl_b32 s95, s9, 6
    s_add_u32 s94, s94, s95
    s_add_u32 s94, s94, 0
    s_add_u32 s95, s94, 56320
    buffer_load_dwordx4 v237, s[52:55], s94 offen lds
    buffer_load_dwordx4 v237, s[52:55], s95 offen offset:1024 lds
    s_mov_b32 s19, 0
    s_swappc_b64 s[10:11], s[80:81]
    s_waitcnt vmcnt(0)
    s_min_u32 s79, s78, s77
    s_cmp_ge_u32 s79, 8
    s_cbranch_scc1 L_RK_62
    s_mov_b32 s86, 0x8000
    s_waitcnt vmcnt(0)
    s_branch POLLC_65
POLL_63:
    s_mov_b32 s76, 0x14000
    buffer_load_dwordx4 v[128:131], v2, s[36:39], s76 offen offset:0 sc1
    buffer_load_dwordx4 v[132:135], v2, s[36:39], s76 offen offset:1024 sc1
    buffer_load_dwordx4 v[136:139], v2, s[36:39], s76 offen offset:2048 sc1
    buffer_load_dwordx4 v[140:143], v2, s[36:39], s76 offen offset:3072 sc1
    s_add_u32 s76, s76, 4096
    buffer_load_dwordx4 v[144:147], v2, s[36:39], s76 offen offset:0 sc1
    buffer_load_dwordx4 v[148:151], v2, s[36:39], s76 offen offset:1024 sc1
    buffer_load_dwordx4 v[152:155], v2, s[36:39], s76 offen offset:2048 sc1
    buffer_load_dwordx4 v[156:159], v2, s[36:39], s76 offen offset:3072 sc1
    s_add_u32 s76, s76, 4096
    buffer_load_dwordx4 v[160:163], v2, s[36:39], s76 offen offset:0 sc1
    buffer_load_dwordx4 v[164:167], v2, s[36:39], s76 offen offset:1024 sc1
    buffer_load_dwordx4 v[168:171], v2, s[36:39], s76 offen offset:2048 sc1
    buffer_load_dwordx4 v[172:175], v2, s[36:39], s76 offen offset:3072 sc1
    s_add_u32 s76, s76, 4096
    buffer_load_dwordx4 v[176:179], v2, s[36:39], s76 offen offset:0 sc1
    buffer_load_dwordx4 v[180:183], v2, s[36:39], s76 offen offset:1024 sc1
    buffer_load_dwordx4 v[184:187], v2, s[36:39], s76 offen offset:2048 sc1
    buffer_load_dwordx4 v[188:191], v2, s[36:39], s76 offen offset:3072 sc1
    s_waitcnt vmcnt(0)
POLLC_65:
    v_or_b32 v192, v128, v130
    v_and_b32 v193, v128, v130
    v_or3_b32 v192, v192, v132, v134
    v_bitop3_b32 v193, v193, v132, v134 bitop3:0x80
    v_or3_b32 v192, v192, v136, v138
    v_bitop3_b32 v193, v193, v136, v138 bitop3:0x80
    v_or3_b32 v192, v192, v140, v142
    v_bitop3_b32 v193, v193, v140, v142 bitop3:0x80
    v_or3_b32 v192, v192, v144, v146
    v_bitop3_b32 v193, v193, v144, v146 bitop3:0x80
    v_or3_b32 v192, v192, v148, v150
    v_bitop3_b32 v193, v193, v148, v150 bitop3:0x80
    v_or3_b32 v192, v192, v152, v154
    v_bitop3_b32 v193, v193, v152, v154 bitop3:0x80
    v_or3_b32 v192, v192, v156, v158
    v_bitop3_b32 v193, v193, v156, v158 bitop3:0x80
    v_or3_b32 v192, v192, v160, v162
    v_bitop3_b32 v193, v193, v160, v162 bitop3:0x80
    v_or3_b32 v192, v192, v164, v166
    v_bitop3_b32 v193, v193, v164, v166 bitop3:0x80
    v_or3_b32 v192, v192, v168, v170
    v_bitop3_b32 v193, v193, v168, v170 bitop3:0x80
    v_or3_b32 v192, v192, v172, v174
    v_bitop3_b32 v193, v193, v172, v174 bitop3:0x80
    v_or3_b32 v192, v192, v176, v178
    v_bitop3_b32 v193, v193, v176, v178 bitop3:0x80
    v_or3_b32 v192, v192, v180, v182
    v_bitop3_b32 v193, v193, v180, v182 bitop3:0x80
    v_or3_b32 v192, v192, v184, v186
    v_bitop3_b32 v193, v193, v184, v186 bitop3:0x80
    v_or3_b32 v192, v192, v188, v190
    v_bitop3_b32 v193, v193, v188, v190 bitop3:0x80
    v_xor_b32 v192, s26, v192
    v_xor_b32 v193, s26, v193
    v_or_b32 v192, v192, v193
    v_cmp_ne_u32 vcc, 0, v192
    s_nop 0
    s_cbranch_vccz POLLD_64
    s_sub_u32 s86, s86, 1
    s_cmp_lg_u32 s86, 0
    s_cbranch_scc1 POLL_63
    v_mov_b32 v192, 13
    buffer_store_dword v192, off, s[64:67], 0
POLLD_64:
    s_cmp_ge_u32 s78, 8
    s_cbranch_scc1 L_NS_66
    v_mov_b32 v194, 0
    v_mov_b32 v195, 0
    v_cmp_lt_u32 s[16:17], s3, v129
    v_cmp_lt_u32 s[18:19], s3, v131
    v_cmp_lt_u32 s[20:21], s3, v133
    v_cmp_lt_u32 s[22:23], s3, v135
    v_addc_co_u32 v194, s[16:17], 0, v194, s[16:17]
    v_addc_co_u32 v195, s[18:19], 0, v195, s[18:19]
    v_addc_co_u32 v194, s[20:21], 0, v194, s[20:21]
    v_addc_co_u32 v195, s[22:23], 0, v195, s[22:23]
    v_cmp_lt_u32 s[16:17], s3, v137
    v_cmp_lt_u32 s[18:19], s3, v139
    v_cmp_lt_u32 s[20:21], s3, v141
    v_cmp_lt_u32 s[22:23], s3, v143
    v_addc_co_u32 v194, s[16:17], 0, v194, s[16:17]
    v_addc_co_u32 v195, s[18:19], 0, v195, s[18:19]
    v_addc_co_u32 v194, s[20:21], 0, v194, s[20:21]
    v_addc_co_u32 v195, s[22:23], 0, v195, s[22:23]
    v_cmp_lt_u32 s[16:17], s3, v145
    v_cmp_lt_u32 s[18:19], s3, v147
    v_cmp_lt_u32 s[20:21], s3, v149
    v_cmp_lt_u32 s[22:23], s3, v151
    v_addc_co_u32 v194, s[16:17], 0, v194, s[16:17]
    v_addc_co_u32 v195, s[18:19], 0, v195, s[18:19]
    v_addc_co_u32 v194, s[20:21], 0, v194, s[20:21]
    v_addc_co_u32 v195, s[22:23], 0, v195, s[22:23]
    v_cmp_lt_u32 s[16:17], s3, v153
    v_cmp_lt_u32 s[18:19], s3, v155
    v_cmp_lt_u32 s[20:21], s3, v157
    v_cmp_lt_u32 s[22:23], s3, v159
    v_addc_co_u32 v194, s[16:17], 0, v194, s[16:17]
    v_addc_co_u32 v195, s[18:19], 0, v195, s[18:19]
    v_addc_co_u32 v194, s[20:21], 0, v194, s[20:21]
    v_addc_co_u32 v195, s[22:23], 0, v195, s[22:23]
    v_cmp_lt_u32 s[16:17], s3, v161
    v_cmp_lt_u32 s[18:19], s3, v163
    v_cmp_lt_u32 s[20:21], s3, v165
    v_cmp_lt_u32 s[22:23], s3, v167
    v_addc_co_u32 v194, s[16:17], 0, v194, s[16:17]
    v_addc_co_u32 v195, s[18:19], 0, v195, s[18:19]
    v_addc_co_u32 v194, s[20:21], 0, v194, s[20:21]
    v_addc_co_u32 v195, s[22:23], 0, v195, s[22:23]
    v_cmp_lt_u32 s[16:17], s3, v169
    v_cmp_lt_u32 s[18:19], s3, v171
    v_cmp_lt_u32 s[20:21], s3, v173
    v_cmp_lt_u32 s[22:23], s3, v175
    v_addc_co_u32 v194, s[16:17], 0, v194, s[16:17]
    v_addc_co_u32 v195, s[18:19], 0, v195, s[18:19]
    v_addc_co_u32 v194, s[20:21], 0, v194, s[20:21]
    v_addc_co_u32 v195, s[22:23], 0, v195, s[22:23]
    v_cmp_lt_u32 s[16:17], s3, v177
    v_cmp_lt_u32 s[18:19], s3, v179
    v_cmp_lt_u32 s[20:21], s3, v181
    v_cmp_lt_u32 s[22:23], s3, v183
    v_addc_co_u32 v194, s[16:17], 0, v194, s[16:17]
    v_addc_co_u32 v195, s[18:19], 0, v195, s[18:19]
    v_addc_co_u32 v194, s[20:21], 0, v194, s[20:21]
    v_addc_co_u32 v195, s[22:23], 0, v195, s[22:23]
    v_cmp_lt_u32 s[16:17], s3, v185
    v_cmp_lt_u32 s[18:19], s3, v187
    v_cmp_lt_u32 s[20:21], s3, v189
    v_cmp_lt_u32 s[22:23], s3, v191
    v_addc_co_u32 v194, s[16:17], 0, v194, s[16:17]
    v_addc_co_u32 v195, s[18:19], 0, v195, s[18:19]
    v_addc_co_u32 v194, s[20:21], 0, v194, s[20:21]
    v_addc_co_u32 v195, s[22:23], 0, v195, s[22:23]
    v_add_u32 v194, v194, v195
    s_nop 1
    v_add_u32_dpp v194, v194, v194 row_shr:1 row_mask:0xf bank_mask:0xf bound_ctrl:0
    s_nop 1
    v_add_u32_dpp v194, v194, v194 row_shr:2 row_mask:0xf bank_mask:0xf bound_ctrl:0
    s_nop 1
    v_add_u32_dpp v194, v194, v194 row_shr:4 row_mask:0xf bank_mask:0xf bound_ctrl:0
    s_nop 1
    v_add_u32_dpp v194, v194, v194 row_shr:8 row_mask:0xf bank_mask:0xf bound_ctrl:0
    s_nop 1
    v_add_u32_dpp v194, v194, v194 row_bcast:15 row_mask:0xa bank_mask:0xf
    s_nop 1
    v_add_u32_dpp v194, v194, v194 row_bcast:31 row_mask:0xc bank_mask:0xf
    s_nop 0
    v_readlane_b32 s78, v194, 63
    s_nop 0
    s_cmp_ge_u32 s78, 8
    s_cbranch_scc1 L_NS_66
    s_lshl_b32 s76, s78, 10
    s_add_u32 s76, s76, 0x8000
    buffer_store_dwordx4 v[244:247], v2, s[36:39], s76 offen sc1
    v_mov_b32 v197, s3
    v_ashrrev_i32 v196, 31, v197
    v_not_b32 v196, v196
    v_or_b32 v196, 0x80000000, v196
    v_xor_b32 v196, v196, v197
    v_and_b32 v196, 0xffff0000, v196
    v_mul_f32 v196, 0xbfb8aa3b, v196
    v_exp_f32 v196, v196
    s_nop 0
    v_add_f32 v196, 1.0, v196
    v_rcp_f32 v196, v196
    s_nop 0
    v_cvt_pk_bf16_f32 v196, v196, v196
    v_and_b32 v196, 0xffff0000, v196
    s_add_u32 s76, s99, 0
    v_or_b32 v14, s76, v196
    s_lshl_b32 s14, s78, 7
    s_add_u32 s14, s14, 0x7000
L_NS_66:
    s_cmp_ge_u32 s77, 8
    s_cbranch_scc1 L_NS_67
    v_mov_b32 v194, 0
    v_mov_b32 v195, 0
    v_cmp_lt_u32 s[16:17], s61, v129
    v_cmp_lt_u32 s[18:19], s61, v131
    v_cmp_lt_u32 s[20:21], s61, v133
    v_cmp_lt_u32 s[22:23], s61, v135
    v_addc_co_u32 v194, s[16:17], 0, v194, s[16:17]
    v_addc_co_u32 v195, s[18:19], 0, v195, s[18:19]
    v_addc_co_u32 v194, s[20:21], 0, v194, s[20:21]
    v_addc_co_u32 v195, s[22:23], 0, v195, s[22:23]
    v_cmp_lt_u32 s[16:17], s61, v137
    v_cmp_lt_u32 s[18:19], s61, v139
    v_cmp_lt_u32 s[20:21], s61, v141
    v_cmp_lt_u32 s[22:23], s61, v143
    v_addc_co_u32 v194, s[16:17], 0, v194, s[16:17]
    v_addc_co_u32 v195, s[18:19], 0, v195, s[18:19]
    v_addc_co_u32 v194, s[20:21], 0, v194, s[20:21]
    v_addc_co_u32 v195, s[22:23], 0, v195, s[22:23]
    v_cmp_lt_u32 s[16:17], s61, v145
    v_cmp_lt_u32 s[18:19], s61, v147
    v_cmp_lt_u32 s[20:21], s61, v149
    v_cmp_lt_u32 s[22:23], s61, v151
    v_addc_co_u32 v194, s[16:17], 0, v194, s[16:17]
    v_addc_co_u32 v195, s[18:19], 0, v195, s[18:19]
    v_addc_co_u32 v194, s[20:21], 0, v194, s[20:21]
    v_addc_co_u32 v195, s[22:23], 0, v195, s[22:23]
    v_cmp_lt_u32 s[16:17], s61, v153
    v_cmp_lt_u32 s[18:19], s61, v155
    v_cmp_lt_u32 s[20:21], s61, v157
    v_cmp_lt_u32 s[22:23], s61, v159
    v_addc_co_u32 v194, s[16:17], 0, v194, s[16:17]
    v_addc_co_u32 v195, s[18:19], 0, v195, s[18:19]
    v_addc_co_u32 v194, s[20:21], 0, v194, s[20:21]
    v_addc_co_u32 v195, s[22:23], 0, v195, s[22:23]
    v_cmp_lt_u32 s[16:17], s61, v161
    v_cmp_lt_u32 s[18:19], s61, v163
    v_cmp_lt_u32 s[20:21], s61, v165
    v_cmp_lt_u32 s[22:23], s61, v167
    v_addc_co_u32 v194, s[16:17], 0, v194, s[16:17]
    v_addc_co_u32 v195, s[18:19], 0, v195, s[18:19]
    v_addc_co_u32 v194, s[20:21], 0, v194, s[20:21]
    v_addc_co_u32 v195, s[22:23], 0, v195, s[22:23]
    v_cmp_lt_u32 s[16:17], s61, v169
    v_cmp_lt_u32 s[18:19], s61, v171
    v_cmp_lt_u32 s[20:21], s61, v173
    v_cmp_lt_u32 s[22:23], s61, v175
    v_addc_co_u32 v194, s[16:17], 0, v194, s[16:17]
    v_addc_co_u32 v195, s[18:19], 0, v195, s[18:19]
    v_addc_co_u32 v194, s[20:21], 0, v194, s[20:21]
    v_addc_co_u32 v195, s[22:23], 0, v195, s[22:23]
    v_cmp_lt_u32 s[16:17], s61, v177
    v_cmp_lt_u32 s[18:19], s61, v179
    v_cmp_lt_u32 s[20:21], s61, v181
    v_cmp_lt_u32 s[22:23], s61, v183
    v_addc_co_u32 v194, s[16:17], 0, v194, s[16:17]
    v_addc_co_u32 v195, s[18:19], 0, v195, s[18:19]
    v_addc_co_u32 v194, s[20:21], 0, v194, s[20:21]
    v_addc_co_u32 v195, s[22:23], 0, v195, s[22:23]
    v_cmp_lt_u32 s[16:17], s61, v185
    v_cmp_lt_u32 s[18:19], s61, v187
    v_cmp_lt_u32 s[20:21], s61, v189
    v_cmp_lt_u32 s[22:23], s61, v191
    v_addc_co_u32 v194, s[16:17], 0, v194, s[16:17]
    v_addc_co_u32 v195, s[18:19], 0, v195, s[18:19]
    v_addc_co_u32 v194, s[20:21], 0, v194, s[20:21]
    v_addc_co_u32 v195, s[22:23], 0, v195, s[22:23]
    v_add_u32 v194, v194, v195
    s_nop 1
    v_add_u32_dpp v194, v194, v194 row_shr:1 row_mask:0xf bank_mask:0xf bound_ctrl:0
    s_nop 1
    v_add_u32_dpp v194, v194, v194 row_shr:2 row_mask:0xf bank_mask:0xf bound_ctrl:0
    s_nop 1
    v_add_u32_dpp v194, v194, v194 row_shr:4 row_mask:0xf bank_mask:0xf bound_ctrl:0
    s_nop 1
    v_add_u32_dpp v194, v194, v194 row_shr:8 row_mask:0xf bank_mask:0xf bound_ctrl:0
    s_nop 1
    v_add_u32_dpp v194, v194, v194 row_bcast:15 row_mask:0xa bank_mask:0xf
    s_nop 1
    v_add_u32_dpp v194, v194, v194 row_bcast:31 row_mask:0xc bank_mask:0xf
    s_nop 0
    v_readlane_b32 s77, v194, 63
    s_nop 0
    s_cmp_ge_u32 s77, 8
    s_cbranch_scc1 L_NS_67
    s_lshl_b32 s76, s77, 10
    s_add_u32 s76, s76, 0x8000
    buffer_store_dwordx4 v[240:243], v2, s[36:39], s76 offen sc1
    v_mov_b32 v197, s61
    v_ashrrev_i32 v196, 31, v197
    v_not_b32 v196, v196
    v_or_b32 v196, 0x80000000, v196
    v_xor_b32 v196, v196, v197
    v_and_b32 v196, 0xffff0000, v196
    v_mul_f32 v196, 0xbfb8aa3b, v196
    v_exp_f32 v196, v196
    s_nop 0
    v_add_f32 v196, 1.0, v196
    v_rcp_f32 v196, v196
    s_nop 0
    v_cvt_pk_bf16_f32 v196, v196, v196
    v_and_b32 v196, 0xffff0000, v196
    s_add_u32 s76, s99, 1
    v_or_b32 v15, s76, v196
    s_lshl_b32 s15, s77, 7
    s_add_u32 s15, s15, 0x7000
L_NS_67:
L_RK_62:
    ds_read_b64_tr_b16 v[192:193], v239 offset:0
    ds_read_b64_tr_b16 v[194:195], v239 offset:256
    ds_read_b64_tr_b16 v[196:197], v239 offset:32
    ds_read_b64_tr_b16 v[198:199], v239 offset:288
    ds_read_b64_tr_b16 v[200:201], v239 offset:2048
    ds_read_b64_tr_b16 v[202:203], v239 offset:2304
    ds_read_b64_tr_b16 v[204:205], v239 offset:2080
    ds_read_b64_tr_b16 v[206:207], v239 offset:2336
    ds_read_b64_tr_b16 v[208:209], v239 offset:4096
    ds_read_b64_tr_b16 v[210:211], v239 offset:4352
    ds_read_b64_tr_b16 v[212:213], v239 offset:4128
    ds_read_b64_tr_b16 v[214:215], v239 offset:4384
    s_mov_b32 s19, 0
    s_swappc_b64 s[10:11], s[80:81]
    s_cmp_eq_u32 s14, 0
    s_cbranch_scc1 L_SP_68
    v_mov_b32 v184, s26
    v_mov_b32 v185, v14
    v_lshlrev_b32 v186, 3, v1
    s_mov_b32 exec_lo, 0xffff
    s_mov_b32 exec_hi, 0
    s_waitcnt vmcnt(0)
    buffer_store_dwordx2 v[184:185], v186, s[36:39], s14 offen sc1
    s_mov_b64 exec, -1
L_SP_68:
    s_cmp_eq_u32 s15, 0
    s_cbranch_scc1 L_SP_69
    v_mov_b32 v184, s26
    v_mov_b32 v185, v15
    v_lshlrev_b32 v186, 3, v1
    s_mov_b32 exec_lo, 0xffff
    s_mov_b32 exec_hi, 0
    s_waitcnt vmcnt(0)
    buffer_store_dwordx2 v[184:185], v186, s[36:39], s15 offen sc1
    s_mov_b64 exec, -1
L_SP_69:
    s_add_u32 m0, s12, 0
    s_mul_i32 s94, s70, 229376
    s_lshl_b32 s95, s9, 6
    s_add_u32 s94, s94, s95
    s_add_u32 s94, s94, 114688
    s_add_u32 s95, s94, 56320
    buffer_load_dwordx4 v237, s[52:55], s94 offen lds
    buffer_load_dwordx4 v237, s[52:55], s95 offen offset:1024 lds
    s_add_u32 s95, s24, s25
    s_add_u32 m0, s12, 2048
    s_add_u32 s94, s95, 15360
    buffer_load_dwordx4 v8, s[40:43], s95 offen lds
    buffer_load_dwordx4 v8, s[40:43], s94 offen offset:1024 lds
    s_add_u32 s25, s25, 32768
    s_and_b32 s25, s25, 0x3ffff
    s_add_u32 s95, s24, s25
    s_add_u32 m0, s12, 4096
    s_add_u32 s94, s95, 15360
    buffer_load_dwordx4 v8, s[40:43], s95 offen lds
    buffer_load_dwordx4 v8, s[40:43], s94 offen offset:1024 lds
    s_add_u32 s25, s25, 32768
    s_and_b32 s25, s25, 0x3ffff
    s_mov_b32 s19, 1
    s_swappc_b64 s[10:11], s[80:81]
    s_waitcnt vmcnt(0)
    ds_read_b64_tr_b16 v[216:217], v239 offset:0
    ds_read_b64_tr_b16 v[218:219], v239 offset:256
    ds_read_b64_tr_b16 v[220:221], v239 offset:32
    ds_read_b64_tr_b16 v[222:223], v239 offset:288
    ds_read_b64_tr_b16 v[128:129], v9 offset:2048
    ds_read_b64_tr_b16 v[130:131], v9 offset:2560
    ds_read_b64_tr_b16 v[132:133], v9 offset:3072
    ds_read_b64_tr_b16 v[134:135], v9 offset:3584
    ds_read_b64_tr_b16 v[136:137], v9 offset:4096
    ds_read_b64_tr_b16 v[138:139], v9 offset:4608
    ds_read_b64_tr_b16 v[140:141], v9 offset:5120
    ds_read_b64_tr_b16 v[142:143], v9 offset:5632
    s_mov_b32 s19, 0
    s_swappc_b64 s[10:11], s[80:81]
    s_add_u32 s95, s24, s25
    s_add_u32 m0, s12, 0
    s_add_u32 s94, s95, 15360
    buffer_load_dwordx4 v8, s[40:43], s95 offen lds
    buffer_load_dwordx4 v8, s[40:43], s94 offen offset:1024 lds
    s_add_u32 s25, s25, 32768
    s_and_b32 s25, s25, 0x3ffff
    s_add_u32 s95, s24, s25
    s_add_u32 m0, s12, 2048
    s_add_u32 s94, s95, 15360
    buffer_load_dwordx4 v8, s[40:43], s95 offen lds
    buffer_load_dwordx4 v8, s[40:43], s94 offen offset:1024 lds
    s_add_u32 s25, s25, 32768
    s_and_b32 s25, s25, 0x3ffff
    s_mov_b32 s95, 0x7000
    s_mov_b32 exec_lo, 0xff
    s_mov_b32 exec_hi, 0x0
    buffer_load_dwordx2 v[14:15], v17, s[36:39], s95 offen sc1
    s_mov_b64 exec, -1
    s_mov_b32 s19, 0
    s_swappc_b64 s[10:11], s[80:81]
    s_mov_b32 s95, 0x7000
    s_mov_b32 exec_lo, 0xff
    s_mov_b32 exec_hi, 0x0
    s_mov_b32 s86, 0x8000
    s_waitcnt vmcnt(0)
    s_branch POLLC_72
POLL_70:
    s_sleep 1
    buffer_load_dwordx2 v[14:15], v17, s[36:39], s95 offen sc1
    s_waitcnt vmcnt(0)
POLLC_72:
    v_cmp_ne_u32 vcc, s26, v14
    s_nop 0
    s_cbranch_vccz POLLD_71
    s_sub_u32 s86, s86, 1
    s_cmp_lg_u32 s86, 0
    s_cbranch_scc1 POLL_70
    v_mov_b32 v241, 6
    buffer_store_dword v241, off, s[64:67], 0
POLLD_71:
    s_mov_b64 exec, -1
    v_and_b32 v247, 7, v1
    v_lshlrev_b32 v247, 10, v247
    v_lshrrev_b32 v246, 4, v1
    v_lshl_add_u32 v247, v246, 4, v247
    s_lshl_b32 s94, s70, 7
    s_add_u32 s94, s94, 0x8000
    buffer_load_dwordx4 v[240:243], v247, s[36:39], s94 offen offset:0 sc1
    buffer_load_dwordx4 v[244:247], v247, s[36:39], s94 offen offset:64 sc1
    ds_read_b64_tr_b16 v[144:145], v9 offset:0
    ds_read_b64_tr_b16 v[146:147], v9 offset:512
    ds_read_b64_tr_b16 v[148:149], v9 offset:1024
    ds_read_b64_tr_b16 v[150:151], v9 offset:1536
    ds_read_b64_tr_b16 v[152:153], v9 offset:2048
    ds_read_b64_tr_b16 v[154:155], v9 offset:2560
    ds_read_b64_tr_b16 v[156:157], v9 offset:3072
    ds_read_b64_tr_b16 v[158:159], v9 offset:3584
    s_mov_b32 s19, 0
    s_swappc_b64 s[10:11], s[80:81]
    s_add_u32 s95, s24, s25
    s_add_u32 m0, s12, 0
    s_add_u32 s94, s95, 15360
    buffer_load_dwordx4 v8, s[40:43], s95 offen lds
    buffer_load_dwordx4 v8, s[40:43], s94 offen offset:1024 lds
    s_add_u32 s25, s25, 32768
    s_and_b32 s25, s25, 0x3ffff
    s_add_u32 s95, s24, s25
    s_add_u32 m0, s12, 2048
    s_add_u32 s94, s95, 15360
    buffer_load_dwordx4 v8, s[40:43], s95 offen lds
    buffer_load_dwordx4 v8, s[40:43], s94 offen offset:1024 lds
    s_add_u32 s25, s25, 32768
    s_and_b32 s25, s25, 0x3ffff
    s_waitcnt vmcnt(4)
    v_mfma_f32_16x16x32_bf16 v[168:171], v[192:195], v[240:243], 0
    v_mfma_f32_16x16x32_bf16 v[172:175], v[196:199], v[240:243], 0
    v_mfma_f32_16x16x32_bf16 v[176:179], v[208:211], v[240:243], 0
    v_mfma_f32_16x16x32_bf16 v[180:183], v[212:215], v[240:243], 0
    v_mfma_f32_16x16x32_bf16 v[168:171], v[200:203], v[244:247], v[168:171]
    v_mfma_f32_16x16x32_bf16 v[172:175], v[204:207], v[244:247], v[172:175]
    v_mfma_f32_16x16x32_bf16 v[176:179], v[216:219], v[244:247], v[176:179]
    v_mfma_f32_16x16x32_bf16 v[180:183], v[220:223], v[244:247], v[180:183]
    v_and_b32 v192, 7, v1
    v_lshlrev_b32 v192, 4, v192
    v_lshrrev_b32 v193, 4, v1
    v_lshl_add_u32 v192, v193, 7, v192
    v_add_u32 v192, s12, v192
    s_mov_b32 exec_lo, 0x00ff00ff
    s_mov_b32 exec_hi, 0x00ff00ff
    ds_write_b128 v192, v[168:171] offset:4096
    ds_write_b128 v192, v[172:175] offset:4608
    ds_write_b128 v192, v[176:179] offset:5120
    ds_write_b128 v192, v[180:183] offset:5632
    s_mov_b64 exec, -1
    v_mov_b32 v184, 155664
    v_mov_b32 v185, 1
    s_mov_b64 exec, 1
    ds_add_u32 v184, v185
    s_mov_b64 exec, -1
    s_mov_b32 s19, 0
    s_swappc_b64 s[10:11], s[80:81]
    s_waitcnt vmcnt(0)
    ds_read_b64_tr_b16 v[160:161], v9 offset:0
    ds_read_b64_tr_b16 v[162:163], v9 offset:512
    ds_read_b64_tr_b16 v[164:165], v9 offset:1024
    ds_read_b64_tr_b16 v[166:167], v9 offset:1536
    ds_read_b64_tr_b16 v[168:169], v9 offset:2048
    ds_read_b64_tr_b16 v[170:171], v9 offset:2560
    ds_read_b64_tr_b16 v[172:173], v9 offset:3072
    ds_read_b64_tr_b16 v[174:175], v9 offset:3584
    s_setprio 0
    s_mov_b32 s19, 0
    s_swappc_b64 s[10:11], s[80:81]
    s_add_u32 s95, s24, s25
    s_add_u32 m0, s12, 0
    s_add_u32 s94, s95, 15360
    buffer_load_dwordx4 v8, s[40:43], s95 offen lds
    buffer_load_dwordx4 v8, s[40:43], s94 offen offset:1024 lds
    s_add_u32 s25, s25, 32768
    s_and_b32 s25, s25, 0x3ffff
    s_add_u32 s95, s24, s25
    s_add_u32 m0, s12, 2048
    s_add_u32 s94, s95, 15360
    buffer_load_dwordx4 v8, s[40:43], s95 offen lds
    buffer_load_dwordx4 v8, s[40:43], s94 offen offset:1024 lds
    s_add_u32 s25, s25, 32768
    s_and_b32 s25, s25, 0x3ffff
    s_mov_b32 s19, 0
    s_swappc_b64 s[10:11], s[80:81]
    s_waitcnt vmcnt(0)
    ds_read_b64_tr_b16 v[176:177], v9 offset:0
    ds_read_b64_tr_b16 v[178:179], v9 offset:512
    ds_read_b64_tr_b16 v[180:181], v9 offset:1024
    ds_read_b64_tr_b16 v[182:183], v9 offset:1536
    ds_read_b64_tr_b16 v[184:185], v9 offset:2048
    ds_read_b64_tr_b16 v[186:187], v9 offset:2560
    ds_read_b64_tr_b16 v[188:189], v9 offset:3072
    ds_read_b64_tr_b16 v[190:191], v9 offset:3584
    s_mov_b32 s19, 0
    s_swappc_b64 s[10:11], s[80:81]
    s_setprio 3
    s_mov_b32 s95, 0x7000
    s_mov_b32 exec_lo, 0xff
    s_mov_b32 exec_hi, 0x0
    s_mov_b32 s86, 0x8000
    s_waitcnt vmcnt(63)
    s_branch POLLC_76
POLL_74:
    s_sleep 1
    buffer_load_dwordx2 v[14:15], v17, s[36:39], s95 offen sc1
    s_waitcnt vmcnt(0)
POLLC_76:
    v_cmp_ne_u32 vcc, s26, v14
    s_nop 0
    s_cbranch_vccz POLLD_75
    s_sub_u32 s86, s86, 1
    s_cmp_lg_u32 s86, 0
    s_cbranch_scc1 POLL_74
    v_mov_b32 v7, 3
    buffer_store_dword v7, off, s[64:67], 0
POLLD_75:
    s_mov_b64 exec, -1
    s_lshl_b32 s95, s69, 3
    s_add_u32 s95, s95, s71
    v_bfe_u32 v7, v15, 5, 6
    s_mov_b64 exec, 0xff
    v_cmp_eq_u32 vcc, s95, v7
    s_mov_b64 exec, -1
    s_mov_b32 s98, vcc_lo
    s_cmp_eq_u32 s98, 0
    s_cbranch_scc1 L_SR_73
    v_lshrrev_b32 v16, 5, v0
    v_lshlrev_b32 v16, 14, v16
    v_and_b32 v7, 31, v0
    v_lshl_add_u32 v16, v7, 4, v16
    s_ff1_i32_b32 s96, s98
    s_lshl_b32 s73, s96, 11
    s_lshl_b32 s74, s72, 9
    s_add_u32 s73, s73, s74
    s_add_u32 s73, s73, 0x20000
    buffer_load_dwordx4 v[224:227], v16, s[36:39], s73 offen sc1
    s_add_u32 s73, s73, 0x40000
    buffer_load_dwordx4 v[228:231], v16, s[36:39], s73 offen sc1
    s_add_u32 s73, s73, 0x40000
    buffer_load_dwordx4 v[232:235], v16, s[36:39], s73 offen sc1
    s_add_u32 s73, s73, 0x40000
    s_cmp_ge_u32 s70, 4
    s_cselect_b32 s74, 0, 1.0
    s_cbranch_scc0 L_Y3_77
    s_sub_u32 s73, s73, 0x40000
L_Y3_77:
    buffer_load_dwordx4 v[236:239], v16, s[36:39], s73 offen sc1
L_SR_73:
    s_setprio 0
    s_mov_b32 s19, 0
    s_swappc_b64 s[10:11], s[80:81]
    s_cmp_eq_u32 s91, 0
    s_cbranch_scc1 L_RUN_EXIT
    s_branch L_ATT_DONE
L_LAG:
    s_setprio 1
    s_mov_b32 s19, 2
    s_call_b64 s[10:11], L_ATT_START
    s_setprio 3
    v_mov_b32 v188, 155648
    s_mov_b32 s86, 0x100000
    s_mov_b32 s76, 0x44f20000
L_AW_79:
    ds_read_b128 v[184:187], v188
    s_waitcnt lgkmcnt(0)
    v_cmp_le_u32 vcc, 12, v186
    v_mul_f32 v184, v184, v185
    s_cbranch_vccnz L_AD_80
    s_sleep 1
    s_sub_u32 s86, s86, 1
    s_cmp_lg_u32 s86, 0
    s_cbranch_scc1 L_AW_79
    v_mov_b32 v185, 14
    buffer_store_dword v185, off, s[64:67], 0
L_AD_80:
    v_cmp_nge_f32 vcc, s76, v184
    s_nop 0
    s_cbranch_vccz L_OK_78
    s_call_b64 s[84:85], L_FALLBACK
L_OK_78:
    s_setprio 1
    s_mov_b32 s19, 0
    s_swappc_b64 s[10:11], s[80:81]
    s_setprio 3
    v_mov_b32 v184, 155660
    v_mov_b32 v185, 1
    s_mov_b64 exec, 1
    ds_add_u32 v184, v185
    s_mov_b64 exec, -1
    v_mov_b32 v187, 155660
    ds_read_b32 v187, v187
    s_mov_b32 s95, 0x7000
    s_mov_b32 exec_lo, 0xff
    s_mov_b32 exec_hi, 0x0
    buffer_load_dwordx2 v[14:15], v17, s[36:39], s95 offen sc1
    s_mov_b64 exec, -1
    s_setprio 1
    s_mov_b32 s19, 0
    s_swappc_b64 s[10:11], s[80:81]
    s_setprio 3
    v_cmp_le_u32 vcc, 8, v187
    s_nop 0
    s_cbranch_vccnz L_CD_82
    v_mov_b32 v184, 155660
    s_mov_b32 s86, 0x100000
L_CW_81:
    ds_read_b32 v185, v184
    s_waitcnt lgkmcnt(0)
    v_cmp_le_u32 vcc, 8, v185
    s_nop 0
    s_cbranch_vccnz L_CD_82
    s_sleep 1
    s_sub_u32 s86, s86, 1
    s_cmp_lg_u32 s86, 0
    s_cbranch_scc1 L_CW_81
    v_mov_b32 v185, 10
    buffer_store_dword v185, off, s[64:67], 0
L_CD_82:
    s_setprio 1
    s_cmp_lg_u32 s87, 0
    s_cbranch_scc1 L_LAGF
    s_add_u32 s95, s24, s25
    s_add_u32 m0, s12, 0
    s_add_u32 s94, s95, 15360
    buffer_load_dwordx4 v8, s[40:43], s95 offen lds
    buffer_load_dwordx4 v8, s[40:43], s94 offen offset:1024 lds
    s_add_u32 s25, s25, 32768
    s_and_b32 s25, s25, 0x3ffff
    s_add_u32 s95, s24, s25
    s_add_u32 m0, s12, 2048
    s_add_u32 s94, s95, 15360
    buffer_load_dwordx4 v8, s[40:43], s95 offen lds
    buffer_load_dwordx4 v8, s[40:43], s94 offen offset:1024 lds
    s_add_u32 s25, s25, 32768
    s_and_b32 s25, s25, 0x3ffff
    s_add_u32 s95, s24, s25
    s_add_u32 m0, s12, 4096
    s_add_u32 s94, s95, 15360
    buffer_load_dwordx4 v8, s[40:43], s95 offen lds
    buffer_load_dwordx4 v8, s[40:43], s94 offen offset:1024 lds
    s_add_u32 s25, s25, 32768
    s_and_b32 s25, s25, 0x3ffff
    s_add_u32 s95, s24, s25
    s_add_u32 m0, s12, 6144
    s_add_u32 s94, s95, 15360
    buffer_load_dwordx4 v8, s[40:43], s95 offen lds
    buffer_load_dwordx4 v8, s[40:43], s94 offen offset:1024 lds
    s_add_u32 s25, s25, 32768
    s_and_b32 s25, s25, 0x3ffff
    s_mov_b32 s19, 1
    s_swappc_b64 s[10:11], s[80:81]
    s_waitcnt vmcnt(0)
    ds_read_b64_tr_b16 v[128:129], v9 offset:0
    ds_read_b64_tr_b16 v[130:131], v9 offset:512
    ds_read_b64_tr_b16 v[132:133], v9 offset:1024
    ds_read_b64_tr_b16 v[134:135], v9 offset:1536
    ds_read_b64_tr_b16 v[136:137], v9 offset:2048
    ds_read_b64_tr_b16 v[138:139], v9 offset:2560
    ds_read_b64_tr_b16 v[140:141], v9 offset:3072
    ds_read_b64_tr_b16 v[142:143], v9 offset:3584
    ds_read_b64_tr_b16 v[144:145], v9 offset:4096
    ds_read_b64_tr_b16 v[146:147], v9 offset:4608
    ds_read_b64_tr_b16 v[148:149], v9 offset:5120
    ds_read_b64_tr_b16 v[150:151], v9 offset:5632
    ds_read_b64_tr_b16 v[152:153], v9 offset:6144
    ds_read_b64_tr_b16 v[154:155], v9 offset:6656
    ds_read_b64_tr_b16 v[156:157], v9 offset:7168
    ds_read_b64_tr_b16 v[158:159], v9 offset:7680
    s_mov_b32 s19, 0
    s_swappc_b64 s[10:11], s[80:81]
    s_add_u32 s95, s24, s25
    s_add_u32 m0, s12, 0
    s_add_u32 s94, s95, 15360
    buffer_load_dwordx4 v8, s[40:43], s95 offen lds
    buffer_load_dwordx4 v8, s[40:43], s94 offen offset:1024 lds
    s_add_u32 s25, s25, 32768
    s_and_b32 s25, s25, 0x3ffff
    s_add_u32 s95, s24, s25
    s_add_u32 m0, s12, 2048
    s_add_u32 s94, s95, 15360
    buffer_load_dwordx4 v8, s[40:43], s95 offen lds
    buffer_load_dwordx4 v8, s[40:43], s94 offen offset:1024 lds
    s_add_u32 s25, s25, 32768
    s_and_b32 s25, s25, 0x3ffff
    s_add_u32 s95, s24, s25
    s_add_u32 m0, s12, 4096
    s_add_u32 s94, s95, 15360
    buffer_load_dwordx4 v8, s[40:43], s95 offen lds
    buffer_load_dwordx4 v8, s[40:43], s94 offen offset:1024 lds
    s_add_u32 s25, s25, 32768
    s_and_b32 s25, s25, 0x3ffff
    s_add_u32 s95, s24, s25
    s_add_u32 m0, s12, 6144
    s_add_u32 s94, s95, 15360
    buffer_load_dwordx4 v8, s[40:43], s95 offen lds
    buffer_load_dwordx4 v8, s[40:43], s94 offen offset:1024 lds
    s_add_u32 s25, s25, 32768
    s_and_b32 s25, s25, 0x3ffff
    s_mov_b32 s19, 1
    s_swappc_b64 s[10:11], s[80:81]
    s_waitcnt vmcnt(0)
    ds_read_b64_tr_b16 v[160:161], v9 offset:0
    ds_read_b64_tr_b16 v[162:163], v9 offset:512
    ds_read_b64_tr_b16 v[164:165], v9 offset:1024
    ds_read_b64_tr_b16 v[166:167], v9 offset:1536
    ds_read_b64_tr_b16 v[168:169], v9 offset:2048
    ds_read_b64_tr_b16 v[170:171], v9 offset:2560
    ds_read_b64_tr_b16 v[172:173], v9 offset:3072
    ds_read_b64_tr_b16 v[174:175], v9 offset:3584
    ds_read_b64_tr_b16 v[176:177], v9 offset:4096
    ds_read_b64_tr_b16 v[178:179], v9 offset:4608
    ds_read_b64_tr_b16 v[180:181], v9 offset:5120
    ds_read_b64_tr_b16 v[182:183], v9 offset:5632
    ds_read_b64_tr_b16 v[184:185], v9 offset:6144
    ds_read_b64_tr_b16 v[186:187], v9 offset:6656
    ds_read_b64_tr_b16 v[188:189], v9 offset:7168
    ds_read_b64_tr_b16 v[190:191], v9 offset:7680
    s_cmp_lg_u32 s70, 7
    s_cbranch_scc1 L_WB_83
    s_cmp_lt_u32 s2, 248
    s_cbranch_scc1 L_WB_83
    buffer_wbl2 sc1
L_WB_83:
    s_mov_b32 s19, 2
    s_swappc_b64 s[10:11], s[80:81]
    s_mov_b32 s95, 0x7000
    s_mov_b32 exec_lo, 0xff
    s_mov_b32 exec_hi, 0x0
    buffer_load_dwordx2 v[14:15], v17, s[36:39], s95 offen sc1
    s_mov_b64 exec, -1
    s_mov_b32 s19, 1
    s_swappc_b64 s[10:11], s[80:81]
    s_setprio 3
    s_mov_b32 s95, 0x7000
    s_mov_b32 exec_lo, 0xff
    s_mov_b32 exec_hi, 0x0
    s_mov_b32 s86, 0x8000
    s_waitcnt vmcnt(0)
    s_branch POLLC_87
POLL_85:
    s_sleep 1
    buffer_load_dwordx2 v[14:15], v17, s[36:39], s95 offen sc1
    s_waitcnt vmcnt(0)
POLLC_87:
    v_cmp_ne_u32 vcc, s26, v14
    s_nop 0
    s_cbranch_vccz POLLD_86
    s_sub_u32 s86, s86, 1
    s_cmp_lg_u32 s86, 0
    s_cbranch_scc1 POLL_85
    v_mov_b32 v7, 3
    buffer_store_dword v7, off, s[64:67], 0
POLLD_86:
    s_mov_b64 exec, -1
    s_lshl_b32 s95, s69, 3
    s_add_u32 s95, s95, s71
    v_bfe_u32 v7, v15, 5, 6
    s_mov_b64 exec, 0xff
    v_cmp_eq_u32 vcc, s95, v7
    s_mov_b64 exec, -1
    s_mov_b32 s98, vcc_lo
    s_cmp_eq_u32 s98, 0
    s_cbranch_scc1 L_SR_84
    v_lshrrev_b32 v16, 5, v0
    v_lshlrev_b32 v16, 14, v16
    v_and_b32 v7, 31, v0
    v_lshl_add_u32 v16, v7, 4, v16
    s_ff1_i32_b32 s96, s98
    s_lshl_b32 s73, s96, 11
    s_lshl_b32 s74, s72, 9
    s_add_u32 s73, s73, s74
    s_add_u32 s73, s73, 0x20000
    buffer_load_dwordx4 v[224:227], v16, s[36:39], s73 offen sc1
    s_add_u32 s73, s73, 0x40000
    buffer_load_dwordx4 v[228:231], v16, s[36:39], s73 offen sc1
    s_add_u32 s73, s73, 0x40000
    buffer_load_dwordx4 v[232:235], v16, s[36:39], s73 offen sc1
    s_add_u32 s73, s73, 0x40000
    s_cmp_ge_u32 s70, 4
    s_cselect_b32 s74, 0, 1.0
    s_cbranch_scc0 L_Y3_88
    s_sub_u32 s73, s73, 0x40000
L_Y3_88:
    buffer_load_dwordx4 v[236:239], v16, s[36:39], s73 offen sc1
L_SR_84:
    s_setprio 1
    s_mov_b32 s19, 0
    s_swappc_b64 s[10:11], s[80:81]
    s_cmp_eq_u32 s91, 0
    s_cbranch_scc1 L_RUN_EXIT
    s_branch L_ATT_DONE
L_LAGF:
    s_add_u32 m0, s12, 0
    s_mul_i32 s94, s70, 229376
    s_lshl_b32 s95, s9, 6
    s_add_u32 s94, s94, s95
    s_add_u32 s94, s94, 0
    s_add_u32 s95, s94, 56320
    buffer_load_dwordx4 v237, s[48:51], s94 offen lds
    buffer_load_dwordx4 v237, s[48:51], s95 offen offset:1024 lds
    s_add_u32 m0, s12, 2048
    s_mul_i32 s94, s70, 229376
    s_lshl_b32 s95, s9, 6
    s_add_u32 s94, s94, s95
    s_add_u32 s94, s94, 114688
    s_add_u32 s95, s94, 56320
    buffer_load_dwordx4 v237, s[48:51], s94 offen lds
    buffer_load_dwordx4 v237, s[48:51], s95 offen offset:1024 lds
    s_add_u32 m0, s12, 4096
    s_mul_i32 s94, s70, 229376
    s_lshl_b32 s95, s9, 6
    s_add_u32 s94, s94, s95
    s_add_u32 s94, s94, 0
    s_add_u32 s95, s94, 56320
    buffer_load_dwordx4 v237, s[52:55], s94 offen lds
    buffer_load_dwordx4 v237, s[52:55], s95 offen offset:1024 lds
    s_add_u32 m0, s12, 6144
    s_mul_i32 s94, s70, 229376
    s_lshl_b32 s95, s9, 6
    s_add_u32 s94, s94, s95
    s_add_u32 s94, s94, 114688
    s_add_u32 s95, s94, 56320
    buffer_load_dwordx4 v237, s[52:55], s94 offen lds
    buffer_load_dwordx4 v237, s[52:55], s95 offen offset:1024 lds
    s_mov_b32 s19, 0
    s_swappc_b64 s[10:11], s[80:81]
    s_setprio 3
    s_mov_b32 s95, 0x7000
    s_mov_b32 exec_lo, 0xff
    s_mov_b32 exec_hi, 0x0
    s_mov_b32 s86, 0x8000
    s_waitcnt vmcnt(0)
    s_branch POLLC_91
POLL_89:
    s_sleep 1
    buffer_load_dwordx2 v[14:15], v17, s[36:39], s95 offen sc1
    s_waitcnt vmcnt(0)
POLLC_91:
    v_cmp_ne_u32 vcc, s26, v14
    s_nop 0
    s_cbranch_vccz POLLD_90
    s_sub_u32 s86, s86, 1
    s_cmp_lg_u32 s86, 0
    s_cbranch_scc1 POLL_89
    v_mov_b32 v241, 6
    buffer_store_dword v241, off, s[64:67], 0
POLLD_90:
    s_mov_b64 exec, -1
    v_and_b32 v247, 7, v1
    v_lshlrev_b32 v247, 10, v247
    v_lshrrev_b32 v246, 4, v1
    v_lshl_add_u32 v247, v246, 4, v247
    s_lshl_b32 s94, s70, 7
    s_add_u32 s94, s94, 0x8000
    buffer_load_dwordx4 v[240:243], v247, s[36:39], s94 offen offset:0 sc1
    buffer_load_dwordx4 v[244:247], v247, s[36:39], s94 offen offset:64 sc1
    ds_read_b64_tr_b16 v[192:193], v239 offset:0
    ds_read_b64_tr_b16 v[194:195], v239 offset:256
    ds_read_b64_tr_b16 v[196:197], v239 offset:32
    ds_read_b64_tr_b16 v[198:199], v239 offset:288
    ds_read_b64_tr_b16 v[200:201], v239 offset:2048
    ds_read_b64_tr_b16 v[202:203], v239 offset:2304
    ds_read_b64_tr_b16 v[204:205], v239 offset:2080
    ds_read_b64_tr_b16 v[206:207], v239 offset:2336
    ds_read_b64_tr_b16 v[208:209], v239 offset:4096
    ds_read_b64_tr_b16 v[210:211], v239 offset:4352
    ds_read_b64_tr_b16 v[212:213], v239 offset:4128
    ds_read_b64_tr_b16 v[214:215], v239 offset:4384
    ds_read_b64_tr_b16 v[216:217], v239 offset:6144
    ds_read_b64_tr_b16 v[218:219], v239 offset:6400
    ds_read_b64_tr_b16 v[220:221], v239 offset:6176
    ds_read_b64_tr_b16 v[222:223], v239 offset:6432
    s_setprio 1
    s_mov_b32 s19, 0
    s_swappc_b64 s[10:11], s[80:81]
    s_setprio 3
    s_add_u32 m0, s12, 0
    s_lshl_b32 s94, s9, 15
    s_lshl_b32 s95, s70, 8
    s_add_u32 s94, s94, s95
    s_add_u32 s94, s94, 4294966400
    s_add_u32 s95, s94, 15360
    buffer_load_dwordx4 v8, s[56:59], s94 offen lds
    buffer_load_dwordx4 v8, s[56:59], s95 offen offset:1024 lds
    s_add_u32 m0, s12, 2048
    s_lshl_b32 s94, s9, 15
    s_lshl_b32 s95, s70, 8
    s_add_u32 s94, s94, s95
    s_add_u32 s94, s94, 4294966464
    s_add_u32 s95, s94, 15360
    buffer_load_dwordx4 v8, s[56:59], s94 offen lds
    buffer_load_dwordx4 v8, s[56:59], s95 offen offset:1024 lds
    s_add_u32 m0, s12, 6144
    s_lshl_b32 s94, s9, 15
    s_lshl_b32 s95, s70, 8
    s_add_u32 s94, s94, s95
    s_add_u32 s94, s94, 4294966272
    s_add_u32 s95, s94, 15360
    buffer_load_dwordx4 v8, s[56:59], s94 offen lds
    buffer_load_dwordx4 v8, s[56:59], s95 offen offset:1024 lds
    s_waitcnt vmcnt(6)
    v_mfma_f32_16x16x32_bf16 v[168:171], v[192:195], v[240:243], 0
    v_mfma_f32_16x16x32_bf16 v[172:175], v[196:199], v[240:243], 0
    v_mfma_f32_16x16x32_bf16 v[176:179], v[208:211], v[240:243], 0
    v_mfma_f32_16x16x32_bf16 v[180:183], v[212:215], v[240:243], 0
    v_mfma_f32_16x16x32_bf16 v[168:171], v[200:203], v[244:247], v[168:171]
    v_mfma_f32_16x16x32_bf16 v[172:175], v[204:207], v[244:247], v[172:175]
    v_mfma_f32_16x16x32_bf16 v[176:179], v[216:219], v[244:247], v[176:179]
    v_mfma_f32_16x16x32_bf16 v[180:183], v[220:223], v[244:247], v[180:183]
    v_and_b32 v192, 7, v1
    v_lshlrev_b32 v192, 4, v192
    v_lshrrev_b32 v193, 4, v1
    v_lshl_add_u32 v192, v193, 7, v192
    v_add_u32 v192, s12, v192
    s_mov_b32 exec_lo, 0x00ff00ff
    s_mov_b32 exec_hi, 0x00ff00ff
    ds_write_b128 v192, v[168:171] offset:4096
    ds_write_b128 v192, v[172:175] offset:4608
    ds_write_b128 v192, v[176:179] offset:5120
    ds_write_b128 v192, v[180:183] offset:5632
    s_mov_b64 exec, -1
    v_mov_b32 v184, 155664
    v_mov_b32 v185, 1
    s_mov_b64 exec, 1
    ds_add_u32 v184, v185
    s_mov_b64 exec, -1
    v_mov_b32 v187, 155664
    ds_read_b32 v187, v187
    s_setprio 1
    s_mov_b32 s19, 0
    s_swappc_b64 s[10:11], s[80:81]
    s_setprio 3
    v_cmp_le_u32 vcc, 8, v187
    s_nop 0
    s_cbranch_vccnz L_CD_93
    v_mov_b32 v184, 155664
    s_mov_b32 s86, 0x100000
L_CW_92:
    ds_read_b32 v185, v184
    s_waitcnt lgkmcnt(0)
    v_cmp_le_u32 vcc, 8, v185
    s_nop 0
    s_cbranch_vccnz L_CD_93
    s_sleep 1
    s_sub_u32 s86, s86, 1
    s_cmp_lg_u32 s86, 0
    s_cbranch_scc1 L_CW_92
    v_mov_b32 v185, 11
    buffer_store_dword v185, off, s[64:67], 0
L_CD_93:
    v_and_b32 v210, 0xff, v0
    v_lshlrev_b32 v209, 2, v210
    v_add_u32 v208, 131072, v209
    ds_read_b32 v192, v208 offset:4096
    ds_read_b32 v200, v208 offset:5120
    ds_read_b32 v193, v208 offset:10240
    ds_read_b32 v201, v208 offset:11264
    ds_read_b32 v194, v208 offset:16384
    ds_read_b32 v202, v208 offset:17408
    ds_read_b32 v195, v208 offset:22528
    ds_read_b32 v203, v208 offset:23552
    ds_read_b32 v196, v209 offset:4096
    ds_read_b32 v204, v209 offset:5120
    ds_read_b32 v197, v209 offset:12288
    ds_read_b32 v205, v209 offset:13312
    ds_read_b32 v198, v209 offset:20480
    ds_read_b32 v206, v209 offset:21504
    ds_read_b32 v199, v209 offset:28672
    ds_read_b32 v207, v209 offset:29696
    v_bfe_u32 v209, v0, 2, 3
    v_lshlrev_b32 v209, 6, v209
    v_lshrrev_b32 v208, 5, v210
    v_lshl_add_u32 v209, v208, 3, v209
    v_and_b32 v208, 3, v0
    v_lshl_add_u32 v209, v208, 1, v209
    v_add_u32 v209, 156160, v209
    s_waitcnt lgkmcnt(0)
    v_add_f32 v192, v192, v193
    v_add_f32 v200, v200, v201
    v_add_f32 v192, v192, v194
    v_add_f32 v200, v200, v202
    v_add_f32 v192, v192, v195
    v_add_f32 v200, v200, v203
    v_add_f32 v192, v192, v196
    v_add_f32 v200, v200, v204
    v_add_f32 v192, v192, v197
    v_add_f32 v200, v200, v205
    v_add_f32 v192, v192, v198
    v_add_f32 v200, v200, v206
    v_add_f32 v192, v192, v199
    v_add_f32 v200, v200, v207
    v_cvt_pk_bf16_f32 v192, v192, v192
    v_lshlrev_b32 v192, 16, v192
    v_cvt_pk_bf16_f32 v200, v200, v200
    v_lshlrev_b32 v200, 16, v200
    v_mul_f32 v208, 0xbfb8aa3b, v192
    v_exp_f32 v208, v208
    s_nop 0
    v_add_f32 v208, 1.0, v208
    v_rcp_f32 v208, v208
    s_nop 0
    v_mul_f32 v208, v208, v192
    v_cvt_pk_bf16_f32 v208, v208, v208
    v_lshlrev_b32 v208, 16, v208
    v_mul_f32 v208, v208, v200
    v_cvt_pk_bf16_f32 v208, v208, v208
    ds_write_b16 v209, v208
    v_mov_b32 v184, 155668
    v_mov_b32 v185, 1
    s_mov_b64 exec, 1
    ds_add_u32 v184, v185
    s_mov_b64 exec, -1
    v_mov_b32 v187, 155668
    ds_read_b32 v187, v187
    s_waitcnt vmcnt(0)
    ds_read_b64_tr_b16 v[208:209], v239 offset:0
    ds_read_b64_tr_b16 v[210:211], v239 offset:256
    ds_read_b64_tr_b16 v[212:213], v239 offset:32
    ds_read_b64_tr_b16 v[214:215], v239 offset:288
    ds_read_b64_tr_b16 v[216:217], v239 offset:2048
    ds_read_b64_tr_b16 v[218:219], v239 offset:2304
    ds_read_b64_tr_b16 v[220:221], v239 offset:2080
    ds_read_b64_tr_b16 v[222:223], v239 offset:2336
    ds_read_b64_tr_b16 v[224:225], v239 offset:6144
    ds_read_b64_tr_b16 v[226:227], v239 offset:6400
    ds_read_b64_tr_b16 v[228:229], v239 offset:6176
    ds_read_b64_tr_b16 v[230:231], v239 offset:6432
    s_waitcnt lgkmcnt(0)
    s_add_u32 m0, s12, 0
    s_lshl_b32 s94, s9, 15
    s_lshl_b32 s95, s70, 8
    s_add_u32 s94, s94, s95
    s_add_u32 s94, s94, 4294966336
    s_add_u32 s95, s94, 15360
    buffer_load_dwordx4 v8, s[56:59], s94 offen lds
    buffer_load_dwordx4 v8, s[56:59], s95 offen offset:1024 lds
    s_setprio 1
    s_mov_b32 s19, 0
    s_swappc_b64 s[10:11], s[80:81]
    s_setprio 3
    v_cmp_le_u32 vcc, 4, v187
    s_nop 0
    s_cbranch_vccnz L_CD_95
    v_mov_b32 v184, 155668
    s_mov_b32 s86, 0x100000
L_CW_94:
    ds_read_b32 v185, v184
    s_waitcnt lgkmcnt(0)
    v_cmp_le_u32 vcc, 4, v185
    s_nop 0
    s_cbranch_vccnz L_CD_95
    s_sleep 1
    s_sub_u32 s86, s86, 1
    s_cmp_lg_u32 s86, 0
    s_cbranch_scc1 L_CW_94
    v_mov_b32 v185, 12
    buffer_store_dword v185, off, s[64:67], 0
L_CD_95:
    s_waitcnt vmcnt(0)
    ds_read_b64_tr_b16 v[232:233], v239 offset:0
    ds_read_b64_tr_b16 v[234:235], v239 offset:256
    ds_read_b64_tr_b16 v[236:237], v239 offset:32
    ds_read_b64_tr_b16 v[238:239], v239 offset:288
    s_add_u32 s95, s24, s25
    s_add_u32 m0, s12, 2048
    s_add_u32 s94, s95, 15360
    buffer_load_dwordx4 v8, s[40:43], s95 offen lds
    buffer_load_dwordx4 v8, s[40:43], s94 offen offset:1024 lds
    s_add_u32 s25, s25, 32768
    s_and_b32 s25, s25, 0x3ffff
    s_add_u32 s95, s24, s25
    s_add_u32 m0, s12, 4096
    s_add_u32 s94, s95, 15360
    buffer_load_dwordx4 v8, s[40:43], s95 offen lds
    buffer_load_dwordx4 v8, s[40:43], s94 offen offset:1024 lds
    s_add_u32 s25, s25, 32768
    s_and_b32 s25, s25, 0x3ffff
    s_add_u32 s95, s24, s25
    s_add_u32 m0, s12, 6144
    s_add_u32 s94, s95, 15360
    buffer_load_dwordx4 v8, s[40:43], s95 offen lds
    buffer_load_dwordx4 v8, s[40:43], s94 offen offset:1024 lds
    s_add_u32 s25, s25, 32768
    s_and_b32 s25, s25, 0x3ffff
    v_and_b32 v188, 7, v1
    v_lshlrev_b32 v189, 11, v188
    v_lshlrev_b32 v188, 6, v188
    v_lshrrev_b32 v190, 4, v1
    v_lshl_add_u32 v188, v190, 4, v188
    v_add_u32 v188, 156160, v188
    ds_read_b128 v[240:243], v188
    v_lshl_add_u32 v189, v190, 4, v189
    v_bfe_u32 v190, v1, 3, 1
    v_lshl_add_u32 v189, v190, 6, v189
    s_mov_b32 vcc_lo, 0xff00ff00
    s_mov_b32 vcc_hi, 0xff00ff00
    s_lshl_b32 s94, s9, 14
    s_lshl_b32 s95, s70, 9
    s_add_u32 s94, s94, s95
    s_add_u32 s94, s94, 0x1f800
    s_mov_b32 s20, 0x3020104
    s_mov_b32 s21, 0x3020105
    s_mov_b32 s22, 0x3020106
    s_mov_b32 s23, 0x3020107
    v_mov_b32 v190, s26
    s_waitcnt lgkmcnt(0)
    v_mfma_f32_16x16x32_bf16 v[192:195], v[224:227], v[240:243], 0
    v_mfma_f32_16x16x32_bf16 v[196:199], v[228:231], v[240:243], 0
    v_mfma_f32_16x16x32_bf16 v[200:203], v[232:235], v[240:243], 0
    v_mfma_f32_16x16x32_bf16 v[204:207], v[236:239], v[240:243], 0
    v_mfma_f32_16x16x32_bf16 v[168:171], v[208:211], v[240:243], 0
    v_mfma_f32_16x16x32_bf16 v[172:175], v[212:215], v[240:243], 0
    v_mfma_f32_16x16x32_bf16 v[176:179], v[216:219], v[240:243], 0
    v_mfma_f32_16x16x32_bf16 v[180:183], v[220:223], v[240:243], 0
    s_nop 1
    v_cndmask_b32 v192, v192, v196, vcc
    v_cndmask_b32 v193, v193, v197, vcc
    v_cndmask_b32 v194, v194, v198, vcc
    v_cndmask_b32 v195, v195, v199, vcc
    v_perm_b32 v192, v190, v192, s20
    v_perm_b32 v193, v190, v193, s21
    v_perm_b32 v194, v190, v194, s22
    v_perm_b32 v195, v190, v195, s23
    buffer_store_dwordx4 v[192:195], v189, s[36:39], s94 offen offset:0 sc1
    v_cndmask_b32 v200, v200, v204, vcc
    v_cndmask_b32 v201, v201, v205, vcc
    v_cndmask_b32 v202, v202, v206, vcc
    v_cndmask_b32 v203, v203, v207, vcc
    v_perm_b32 v200, v190, v200, s20
    v_perm_b32 v201, v190, v201, s21
    v_perm_b32 v202, v190, v202, s22
    v_perm_b32 v203, v190, v203, s23
    buffer_store_dwordx4 v[200:203], v189, s[36:39], s94 offen offset:128 sc1
    v_cndmask_b32 v168, v168, v172, vcc
    v_cndmask_b32 v169, v169, v173, vcc
    v_cndmask_b32 v170, v170, v174, vcc
    v_cndmask_b32 v171, v171, v175, vcc
    v_perm_b32 v168, v190, v168, s20
    v_perm_b32 v169, v190, v169, s21
    v_perm_b32 v170, v190, v170, s22
    v_perm_b32 v171, v190, v171, s23
    buffer_store_dwordx4 v[168:171], v189, s[36:39], s94 offen offset:256 sc1
    v_cndmask_b32 v176, v176, v180, vcc
    v_cndmask_b32 v177, v177, v181, vcc
    v_cndmask_b32 v178, v178, v182, vcc
    v_cndmask_b32 v179, v179, v183, vcc
    v_perm_b32 v176, v190, v176, s20
    v_perm_b32 v177, v190, v177, s21
    v_perm_b32 v178, v190, v178, s22
    v_perm_b32 v179, v190, v179, s23
    buffer_store_dwordx4 v[176:179], v189, s[36:39], s94 offen offset:384 sc1
    s_setprio 1
    s_mov_b32 s19, 0
    s_swappc_b64 s[10:11], s[80:81]
    s_add_u32 s95, s24, s25
    s_add_u32 m0, s12, 0
    s_add_u32 s94, s95, 15360
    buffer_load_dwordx4 v8, s[40:43], s95 offen lds
    buffer_load_dwordx4 v8, s[40:43], s94 offen offset:1024 lds
    s_add_u32 s25, s25, 32768
    s_and_b32 s25, s25, 0x3ffff
    s_mov_b32 s19, 0
    s_swappc_b64 s[10:11], s[80:81]
    s_waitcnt vmcnt(0)
    ds_read_b64_tr_b16 v[128:129], v9 offset:2048
    ds_read_b64_tr_b16 v[130:131], v9 offset:2560
    ds_read_b64_tr_b16 v[132:133], v9 offset:3072
    ds_read_b64_tr_b16 v[134:135], v9 offset:3584
    ds_read_b64_tr_b16 v[136:137], v9 offset:4096
    ds_read_b64_tr_b16 v[138:139], v9 offset:4608
    ds_read_b64_tr_b16 v[140:141], v9 offset:5120
    ds_read_b64_tr_b16 v[142:143], v9 offset:5632
    ds_read_b64_tr_b16 v[144:145], v9 offset:6144
    ds_read_b64_tr_b16 v[146:147], v9 offset:6656
    ds_read_b64_tr_b16 v[148:149], v9 offset:7168
    ds_read_b64_tr_b16 v[150:151], v9 offset:7680
    ds_read_b64_tr_b16 v[152:153], v9 offset:0
    ds_read_b64_tr_b16 v[154:155], v9 offset:512
    ds_read_b64_tr_b16 v[156:157], v9 offset:1024
    ds_read_b64_tr_b16 v[158:159], v9 offset:1536
    s_mov_b32 s19, 0
    s_swappc_b64 s[10:11], s[80:81]
    s_add_u32 s95, s24, s25
    s_add_u32 m0, s12, 0
    s_add_u32 s94, s95, 15360
    buffer_load_dwordx4 v8, s[40:43], s95 offen lds
    buffer_load_dwordx4 v8, s[40:43], s94 offen offset:1024 lds
    s_add_u32 s25, s25, 32768
    s_and_b32 s25, s25, 0x3ffff
    s_add_u32 s95, s24, s25
    s_add_u32 m0, s12, 2048
    s_add_u32 s94, s95, 15360
    buffer_load_dwordx4 v8, s[40:43], s95 offen lds
    buffer_load_dwordx4 v8, s[40:43], s94 offen offset:1024 lds
    s_add_u32 s25, s25, 32768
    s_and_b32 s25, s25, 0x3ffff
    s_add_u32 s95, s24, s25
    s_add_u32 m0, s12, 4096
    s_add_u32 s94, s95, 15360
    buffer_load_dwordx4 v8, s[40:43], s95 offen lds
    buffer_load_dwordx4 v8, s[40:43], s94 offen offset:1024 lds
    s_add_u32 s25, s25, 32768
    s_and_b32 s25, s25, 0x3ffff
    s_add_u32 s95, s24, s25
    s_add_u32 m0, s12, 6144
    s_add_u32 s94, s95, 15360
    buffer_load_dwordx4 v8, s[40:43], s95 offen lds
    buffer_load_dwordx4 v8, s[40:43], s94 offen offset:1024 lds
    s_add_u32 s25, s25, 32768
    s_and_b32 s25, s25, 0x3ffff
    s_mov_b32 s19, 1
    s_swappc_b64 s[10:11], s[80:81]
    s_waitcnt vmcnt(0)
    ds_read_b64_tr_b16 v[160:161], v9 offset:0
    ds_read_b64_tr_b16 v[162:163], v9 offset:512
    ds_read_b64_tr_b16 v[164:165], v9 offset:1024
    ds_read_b64_tr_b16 v[166:167], v9 offset:1536
    ds_read_b64_tr_b16 v[168:169], v9 offset:2048
    ds_read_b64_tr_b16 v[170:171], v9 offset:2560
    ds_read_b64_tr_b16 v[172:173], v9 offset:3072
    ds_read_b64_tr_b16 v[174:175], v9 offset:3584
    ds_read_b64_tr_b16 v[176:177], v9 offset:4096
    ds_read_b64_tr_b16 v[178:179], v9 offset:4608
    ds_read_b64_tr_b16 v[180:181], v9 offset:5120
    ds_read_b64_tr_b16 v[182:183], v9 offset:5632
    ds_read_b64_tr_b16 v[184:185], v9 offset:6144
    ds_read_b64_tr_b16 v[186:187], v9 offset:6656
    ds_read_b64_tr_b16 v[188:189], v9 offset:7168
    ds_read_b64_tr_b16 v[190:191], v9 offset:7680
    s_mov_b32 s19, 0
    s_swappc_b64 s[10:11], s[80:81]
    s_setprio 3
    s_mov_b32 s95, 0x7000
    s_mov_b32 exec_lo, 0xff
    s_mov_b32 exec_hi, 0x0
    s_mov_b32 s86, 0x8000
    s_waitcnt vmcnt(63)
    s_branch POLLC_99
POLL_97:
    s_sleep 1
    buffer_load_dwordx2 v[14:15], v17, s[36:39], s95 offen sc1
    s_waitcnt vmcnt(0)
POLLC_99:
    v_cmp_ne_u32 vcc, s26, v14
    s_nop 0
    s_cbranch_vccz POLLD_98
    s_sub_u32 s86, s86, 1
    s_cmp_lg_u32 s86, 0
    s_cbranch_scc1 POLL_97
    v_mov_b32 v7, 3
    buffer_store_dword v7, off, s[64:67], 0
POLLD_98:
    s_mov_b64 exec, -1
    s_lshl_b32 s95, s69, 3
    s_add_u32 s95, s95, s71
    v_bfe_u32 v7, v15, 5, 6
    s_mov_b64 exec, 0xff
    v_cmp_eq_u32 vcc, s95, v7
    s_mov_b64 exec, -1
    s_mov_b32 s98, vcc_lo
    s_cmp_eq_u32 s98, 0
    s_cbranch_scc1 L_SR_96
    v_lshrrev_b32 v16, 5, v0
    v_lshlrev_b32 v16, 14, v16
    v_and_b32 v7, 31, v0
    v_lshl_add_u32 v16, v7, 4, v16
    s_ff1_i32_b32 s96, s98
    s_lshl_b32 s73, s96, 11
    s_lshl_b32 s74, s72, 9
    s_add_u32 s73, s73, s74
    s_add_u32 s73, s73, 0x20000
    buffer_load_dwordx4 v[224:227], v16, s[36:39], s73 offen sc1
    s_add_u32 s73, s73, 0x40000
    buffer_load_dwordx4 v[228:231], v16, s[36:39], s73 offen sc1
    s_add_u32 s73, s73, 0x40000
    buffer_load_dwordx4 v[232:235], v16, s[36:39], s73 offen sc1
    s_add_u32 s73, s73, 0x40000
    s_cmp_ge_u32 s70, 4
    s_cselect_b32 s74, 0, 1.0
    s_cbranch_scc0 L_Y3_100
    s_sub_u32 s73, s73, 0x40000
L_Y3_100:
    buffer_load_dwordx4 v[236:239], v16, s[36:39], s73 offen sc1
L_SR_96:
    s_setprio 1
    s_mov_b32 s19, 0
    s_swappc_b64 s[10:11], s[80:81]
    s_cmp_eq_u32 s91, 0
    s_cbranch_scc1 L_RUN_EXIT
    s_branch L_ATT_DONE
L_CODE_END:
    s_endpgm
.section .rodata,"a"
.p2align 6
.amdhsa_kernel recurrent_scan__mha_block__moe_arch_mod__prompt_kernel
  .amdhsa_next_free_vgpr 256
  .amdhsa_next_free_sgpr 102
  .amdhsa_accum_offset 256
  .amdhsa_group_segment_fixed_size 0
  .amdhsa_kernarg_size 88
  .amdhsa_user_sgpr_count 2
  .amdhsa_user_sgpr_kernarg_segment_ptr 1
  .amdhsa_system_sgpr_workgroup_id_x 1
  .amdhsa_float_denorm_mode_32 3
.end_amdhsa_kernel
```
